```python
import torch

def _softmax(x, axis=-1):
    return torch.softmax(x, dim=axis)
def _gelu(x):
    return torch.nn.functional.gelu(x, approximate="tanh")
def _silu(x):
    return torch.nn.functional.silu(x)
def _sigmoid(x):
    return torch.sigmoid(x)
def _layernorm(x, axis=-1, eps=1e-5):
    m = x.mean(dim=axis, keepdim=True)
    v = x.var(dim=axis, keepdim=True, unbiased=False)
    return (x - m) / torch.sqrt(v + eps)
def _scatter_add(tgt, idx, src, axis=0):
    return tgt.clone().index_add_(axis, idx, src)
def _segment_sum(src, seg, n):
    out = torch.zeros((n,) + src.shape[1:], dtype=src.dtype)
    return out.index_add_(0, seg, src)
def _pad(x, pw):
    flat = tuple(v for pair in reversed(pw) for v in pair)
    return torch.nn.functional.pad(x, flat)

kernel_name = 'standalone__mha_block_cached__near_ridge'

def setup_inputs():

    _w = (lambda a: (lambda t: t.to(torch.bfloat16) if t.is_floating_point() else t)(torch.as_tensor(a)))
    B, Sq, D = 16, 96, 640
    H, Sk, Dh = 32, 1024, 192
    return {
        "x": _w((lambda *s: torch.randn(*s, dtype=torch.bfloat16) * 0.8)(B, Sq, D)),
        "k_cache": _w((lambda *s: torch.randn(*s, dtype=torch.bfloat16) * 0.8)(B, H, Sk, Dh)),
        "v_cache": _w((lambda *s: torch.randn(*s, dtype=torch.bfloat16) * 0.05)(B, H, Sk, Dh)),
        "wq": _w((lambda *s: torch.randn(*s, dtype=torch.bfloat16) * 0.8)(D, H * Dh) * (D ** -0.5)),
        "wo": _w((lambda *s: torch.randn(*s, dtype=torch.bfloat16) * 0.05)(H * Dh, D) * ((H * Dh) ** -0.5)),
    }

def reference(x, k_cache, v_cache, wq, wo):
    B, Sq, D = x.shape
    H, Dh = 32, 192
    q = (lambda x, *d: x.permute(*d))((x @ wq).reshape(B, Sq, H, Dh), 0, 2, 1, 3)
    scores = torch.einsum("bhqd,bhkd->bhqk", q, k_cache) * (Dh ** -0.5)
    p = _softmax(scores, axis=-1)
    o = torch.einsum("bhqk,bhkd->bhqd", p, v_cache)
    return (lambda x, *d: x.permute(*d))(o, 0, 2, 1, 3).reshape(B, Sq, H * Dh) @ wo
```

```asm
; @launch kernel=standalone__mha_block_cached__near_ridge_kernel grid=(256,1,1) block=(512,1,1) lds=147456
; @launch kernel=oproj_kernel grid=(240,1,1) block=(384,1,1) lds=131072
; @launch kernel=reduce_kernel grid=(960,1,1) block=(256,1,1) lds=0
.amdgcn_target "amdgcn-amd-amdhsa--gfx950"
.text
.globl standalone__mha_block_cached__near_ridge_kernel
.p2align 8
.type standalone__mha_block_cached__near_ridge_kernel,@function
standalone__mha_block_cached__near_ridge_kernel:
    s_cmp_ge_u32 s2, 256
    s_cbranch_scc1 L1_end
    s_load_dwordx8 s[28:35], s[0:1], 0
    s_load_dwordx2 s[36:37], s[0:1], 56
    s_load_dwordx2 s[50:51], s[0:1], 48
    s_load_dwordx2 s[92:93], s[0:1], 32
    v_lshrrev_b32 v1, 6, v0
    v_and_b32 v2, 63, v0
    v_readfirstlane_b32 s40, v1
    s_and_b32 s39, s2, 31
    s_lshr_b32 s38, s2, 5
    s_lshr_b32 s3, s40, 2
    s_and_b32 s40, s40, 3
    s_lshr_b32 s55, s39, 3
    s_mul_i32 s55, s55, 3
    s_add_u32 s55, s55, s38
    s_cmp_ge_u32 s55, 10
    s_cselect_b32 s54, 10, 0
    s_sub_u32 s55, s55, s54
    s_waitcnt lgkmcnt(0)
    s_mov_b32 s8, s28
    s_and_b32 s9, s29, 0xffff
    s_mov_b32 s10, 1966080
    s_mov_b32 s11, 0x00020000
    s_mov_b32 s12, s30
    s_and_b32 s13, s31, 0xffff
    s_mov_b32 s14, 201326592
    s_mov_b32 s15, 0x00020000
    s_mov_b32 s16, s32
    s_and_b32 s17, s33, 0xffff
    s_mov_b32 s18, 201326592
    s_mov_b32 s19, 0x00020000
    s_mov_b32 s20, s34
    s_and_b32 s21, s35, 0xffff
    s_mov_b32 s22, 7864320
    s_mov_b32 s23, 0x00020000
    s_mov_b32 s24, s36
    s_and_b32 s25, s37, 0xffff
    s_mov_b32 s26, 18874368
    s_mov_b32 s27, 0x00020000
    s_mov_b32 s96, s92
    s_and_b32 s97, s93, 0xffff
    s_mov_b32 s98, 7864320
    s_mov_b32 s99, 0x00020000
    s_cmp_eq_u32 s40, 3
    s_cbranch_scc0 L1_compute
    v_add_u32 v3, 0, v2
    v_mul_u32_u24 v4, 0xaab, v3
    v_lshrrev_b32 v4, 16, v4
    v_mul_u32_u24 v5, 24, v4
    v_sub_u32 v5, v3, v5
    v_lshrrev_b32 v6, 1, v4
    v_and_b32 v7, 7, v6
    v_xor_b32 v7, v7, v5
    v_lshlrev_b32 v7, 4, v7
    v_mul_u32_u24 v8, 0x180, v4
    v_add_u32 v10, v7, v8
    v_and_b32 v7, 1, v6
    v_lshlrev_b32 v7, 2, v7
    v_xor_b32 v7, v7, v5
    v_lshlrev_b32 v7, 4, v7
    v_add_u32 v16, v7, v8
    v_mul_u32_u24 v8, 0x3000, v4
    v_add_u32 v19, v7, v8
    v_add_u32 v3, 64, v2
    v_mul_u32_u24 v4, 0xaab, v3
    v_lshrrev_b32 v4, 16, v4
    v_mul_u32_u24 v5, 24, v4
    v_sub_u32 v5, v3, v5
    v_lshrrev_b32 v6, 1, v4
    v_and_b32 v7, 7, v6
    v_xor_b32 v7, v7, v5
    v_lshlrev_b32 v7, 4, v7
    v_mul_u32_u24 v8, 0x180, v4
    v_add_u32 v11, v7, v8
    v_and_b32 v7, 1, v6
    v_lshlrev_b32 v7, 2, v7
    v_xor_b32 v7, v7, v5
    v_lshlrev_b32 v7, 4, v7
    v_add_u32 v17, v7, v8
    v_mul_u32_u24 v8, 0x3000, v4
    v_add_u32 v20, v7, v8
    v_add_u32 v3, 128, v2
    v_mul_u32_u24 v4, 0xaab, v3
    v_lshrrev_b32 v4, 16, v4
    v_mul_u32_u24 v5, 24, v4
    v_sub_u32 v5, v3, v5
    v_lshrrev_b32 v6, 1, v4
    v_and_b32 v7, 7, v6
    v_xor_b32 v7, v7, v5
    v_lshlrev_b32 v7, 4, v7
    v_mul_u32_u24 v8, 0x180, v4
    v_add_u32 v12, v7, v8
    v_and_b32 v7, 1, v6
    v_lshlrev_b32 v7, 2, v7
    v_xor_b32 v7, v7, v5
    v_lshlrev_b32 v7, 4, v7
    v_add_u32 v18, v7, v8
    v_mul_u32_u24 v8, 0x3000, v4
    v_add_u32 v21, v7, v8
    v_add_u32 v3, 192, v2
    v_mul_u32_u24 v4, 0xaab, v3
    v_lshrrev_b32 v4, 16, v4
    v_mul_u32_u24 v5, 24, v4
    v_sub_u32 v5, v3, v5
    v_lshrrev_b32 v6, 1, v4
    v_and_b32 v7, 7, v6
    v_xor_b32 v7, v7, v5
    v_lshlrev_b32 v7, 4, v7
    v_mul_u32_u24 v8, 0x180, v4
    v_add_u32 v13, v7, v8
    v_add_u32 v3, 256, v2
    v_mul_u32_u24 v4, 0xaab, v3
    v_lshrrev_b32 v4, 16, v4
    v_mul_u32_u24 v5, 24, v4
    v_sub_u32 v5, v3, v5
    v_lshrrev_b32 v6, 1, v4
    v_and_b32 v7, 7, v6
    v_xor_b32 v7, v7, v5
    v_lshlrev_b32 v7, 4, v7
    v_mul_u32_u24 v8, 0x180, v4
    v_add_u32 v14, v7, v8
    v_add_u32 v3, 320, v2
    v_mul_u32_u24 v4, 0xaab, v3
    v_lshrrev_b32 v4, 16, v4
    v_mul_u32_u24 v5, 24, v4
    v_sub_u32 v5, v3, v5
    v_lshrrev_b32 v6, 1, v4
    v_and_b32 v7, 7, v6
    v_xor_b32 v7, v7, v5
    v_lshlrev_b32 v7, 4, v7
    v_mul_u32_u24 v8, 0x180, v4
    v_add_u32 v15, v7, v8
    s_lshl_b32 s41, s38, 5
    s_add_u32 s41, s41, s39
    s_mul_i32 s41, s41, 393216
    s_add_u32 s42, s41, 100663296
    s_mul_i32 s43, s39, 384
    s_mul_i32 s45, s3, 12288
    s_mul_i32 s47, s55, 786432
    v_lshlrev_b32 v22, 4, v2
    v_add_u32 v22, s45, v22
    s_cmp_eq_u32 s3, 0
    s_cbranch_scc0 L1_loader1
    s_mov_b32 m0, 0
    s_add_u32 s46, s43, s47
    s_add_u32 s47, s47, 786432
    s_cmp_eq_u32 s47, 7864320
    s_cselect_b32 s47, 0, s47
    buffer_load_dwordx4 v19, s[20:23], s46 offen  lds
    s_add_u32 m0, m0, 0x400
    s_nop 0
    buffer_load_dwordx4 v20, s[20:23], s46 offen  lds
    s_add_u32 m0, m0, 0x400
    s_nop 0
    buffer_load_dwordx4 v21, s[20:23], s46 offen  lds
    s_add_u32 m0, m0, 0x400
    s_add_u32 s46, s46, 98304
    buffer_load_dwordx4 v19, s[20:23], s46 offen  lds
    s_add_u32 m0, m0, 0x400
    s_nop 0
    buffer_load_dwordx4 v20, s[20:23], s46 offen  lds
    s_add_u32 m0, m0, 0x400
    s_nop 0
    buffer_load_dwordx4 v21, s[20:23], s46 offen  lds
    s_add_u32 m0, m0, 0x400
    s_add_u32 s46, s46, 98304
    buffer_load_dwordx4 v19, s[20:23], s46 offen  lds
    s_add_u32 m0, m0, 0x400
    s_nop 0
    buffer_load_dwordx4 v20, s[20:23], s46 offen  lds
    s_add_u32 m0, m0, 0x400
    s_nop 0
    buffer_load_dwordx4 v21, s[20:23], s46 offen  lds
    s_add_u32 m0, m0, 0x400
    s_add_u32 s46, s46, 98304
    buffer_load_dwordx4 v19, s[20:23], s46 offen  lds
    s_add_u32 m0, m0, 0x400
    s_nop 0
    buffer_load_dwordx4 v20, s[20:23], s46 offen  lds
    s_add_u32 m0, m0, 0x400
    s_nop 0
    buffer_load_dwordx4 v21, s[20:23], s46 offen  lds
    s_add_u32 m0, m0, 0x400
    s_add_u32 s46, s46, 98304
    s_mov_b32 m0, 24576
    s_add_u32 s46, s43, s47
    s_add_u32 s47, s47, 786432
    s_cmp_eq_u32 s47, 7864320
    s_cselect_b32 s47, 0, s47
    buffer_load_dwordx4 v19, s[20:23], s46 offen  lds
    s_add_u32 m0, m0, 0x400
    s_nop 0
    buffer_load_dwordx4 v20, s[20:23], s46 offen  lds
    s_add_u32 m0, m0, 0x400
    s_nop 0
    buffer_load_dwordx4 v21, s[20:23], s46 offen  lds
    s_add_u32 m0, m0, 0x400
    s_add_u32 s46, s46, 98304
    buffer_load_dwordx4 v19, s[20:23], s46 offen  lds
    s_add_u32 m0, m0, 0x400
    s_nop 0
    buffer_load_dwordx4 v20, s[20:23], s46 offen  lds
    s_add_u32 m0, m0, 0x400
    s_nop 0
    buffer_load_dwordx4 v21, s[20:23], s46 offen  lds
    s_add_u32 m0, m0, 0x400
    s_add_u32 s46, s46, 98304
    buffer_load_dwordx4 v19, s[20:23], s46 offen  lds
    s_add_u32 m0, m0, 0x400
    s_nop 0
    buffer_load_dwordx4 v20, s[20:23], s46 offen  lds
    s_add_u32 m0, m0, 0x400
    s_nop 0
    buffer_load_dwordx4 v21, s[20:23], s46 offen  lds
    s_add_u32 m0, m0, 0x400
    s_add_u32 s46, s46, 98304
    buffer_load_dwordx4 v19, s[20:23], s46 offen  lds
    s_add_u32 m0, m0, 0x400
    s_nop 0
    buffer_load_dwordx4 v20, s[20:23], s46 offen  lds
    s_add_u32 m0, m0, 0x400
    s_nop 0
    buffer_load_dwordx4 v21, s[20:23], s46 offen  lds
    s_add_u32 m0, m0, 0x400
    s_add_u32 s46, s46, 98304
    s_waitcnt vmcnt(12)
    s_waitcnt lgkmcnt(0)
    s_barrier
    s_mov_b32 m0, 49152
    s_add_u32 s46, s43, s47
    buffer_load_dwordx4 v19, s[20:23], s46 offen  lds
    s_add_u32 m0, m0, 0x400
    s_nop 0
    buffer_load_dwordx4 v20, s[20:23], s46 offen  lds
    s_add_u32 m0, m0, 0x400
    s_nop 0
    buffer_load_dwordx4 v21, s[20:23], s46 offen  lds
    s_add_u32 m0, m0, 0x400
    s_add_u32 s46, s46, 98304
    buffer_load_dwordx4 v19, s[20:23], s46 offen  lds
    s_add_u32 m0, m0, 0x400
    s_nop 0
    buffer_load_dwordx4 v20, s[20:23], s46 offen  lds
    s_add_u32 m0, m0, 0x400
    s_nop 0
    buffer_load_dwordx4 v21, s[20:23], s46 offen  lds
    s_add_u32 m0, m0, 0x400
    s_add_u32 s46, s46, 98304
    buffer_load_dwordx4 v19, s[20:23], s46 offen  lds
    s_add_u32 m0, m0, 0x400
    s_nop 0
    buffer_load_dwordx4 v20, s[20:23], s46 offen  lds
    s_add_u32 m0, m0, 0x400
    s_nop 0
    buffer_load_dwordx4 v21, s[20:23], s46 offen  lds
    s_add_u32 m0, m0, 0x400
    s_add_u32 s46, s46, 98304
    buffer_load_dwordx4 v19, s[20:23], s46 offen  lds
    s_add_u32 m0, m0, 0x400
    s_nop 0
    buffer_load_dwordx4 v20, s[20:23], s46 offen  lds
    s_add_u32 m0, m0, 0x400
    s_nop 0
    buffer_load_dwordx4 v21, s[20:23], s46 offen  lds
    s_add_u32 m0, m0, 0x400
    s_add_u32 s46, s46, 98304
    s_mov_b32 m0, 61440
    s_add_u32 s46, s43, s47
    s_add_u32 s46, s46, 393216
    s_add_u32 s47, s47, 786432
    s_cmp_eq_u32 s47, 7864320
    s_cselect_b32 s47, 0, s47
    buffer_load_dwordx4 v19, s[20:23], s46 offen  lds
    s_add_u32 m0, m0, 0x400
    s_nop 0
    buffer_load_dwordx4 v20, s[20:23], s46 offen  lds
    s_add_u32 m0, m0, 0x400
    s_nop 0
    buffer_load_dwordx4 v21, s[20:23], s46 offen  lds
    s_add_u32 m0, m0, 0x400
    s_add_u32 s46, s46, 98304
    buffer_load_dwordx4 v19, s[20:23], s46 offen  lds
    s_add_u32 m0, m0, 0x400
    s_nop 0
    buffer_load_dwordx4 v20, s[20:23], s46 offen  lds
    s_add_u32 m0, m0, 0x400
    s_nop 0
    buffer_load_dwordx4 v21, s[20:23], s46 offen  lds
    s_add_u32 m0, m0, 0x400
    s_add_u32 s46, s46, 98304
    buffer_load_dwordx4 v19, s[20:23], s46 offen  lds
    s_add_u32 m0, m0, 0x400
    s_nop 0
    buffer_load_dwordx4 v20, s[20:23], s46 offen  lds
    s_add_u32 m0, m0, 0x400
    s_nop 0
    buffer_load_dwordx4 v21, s[20:23], s46 offen  lds
    s_add_u32 m0, m0, 0x400
    s_add_u32 s46, s46, 98304
    buffer_load_dwordx4 v19, s[20:23], s46 offen  lds
    s_add_u32 m0, m0, 0x400
    s_nop 0
    buffer_load_dwordx4 v20, s[20:23], s46 offen  lds
    s_add_u32 m0, m0, 0x400
    s_nop 0
    buffer_load_dwordx4 v21, s[20:23], s46 offen  lds
    s_add_u32 m0, m0, 0x400
    s_add_u32 s46, s46, 98304
    s_waitcnt vmcnt(24)
    s_waitcnt lgkmcnt(0)
    s_barrier
    s_mov_b32 m0, 73728
    s_add_u32 s46, s43, s47
    buffer_load_dwordx4 v19, s[20:23], s46 offen  lds
    s_add_u32 m0, m0, 0x400
    s_nop 0
    buffer_load_dwordx4 v20, s[20:23], s46 offen  lds
    s_add_u32 m0, m0, 0x400
    s_nop 0
    buffer_load_dwordx4 v21, s[20:23], s46 offen  lds
    s_add_u32 m0, m0, 0x400
    s_add_u32 s46, s46, 98304
    buffer_load_dwordx4 v19, s[20:23], s46 offen  lds
    s_add_u32 m0, m0, 0x400
    s_nop 0
    buffer_load_dwordx4 v20, s[20:23], s46 offen  lds
    s_add_u32 m0, m0, 0x400
    s_nop 0
    buffer_load_dwordx4 v21, s[20:23], s46 offen  lds
    s_add_u32 m0, m0, 0x400
    s_add_u32 s46, s46, 98304
    buffer_load_dwordx4 v19, s[20:23], s46 offen  lds
    s_add_u32 m0, m0, 0x400
    s_nop 0
    buffer_load_dwordx4 v20, s[20:23], s46 offen  lds
    s_add_u32 m0, m0, 0x400
    s_nop 0
    buffer_load_dwordx4 v21, s[20:23], s46 offen  lds
    s_add_u32 m0, m0, 0x400
    s_add_u32 s46, s46, 98304
    buffer_load_dwordx4 v19, s[20:23], s46 offen  lds
    s_add_u32 m0, m0, 0x400
    s_nop 0
    buffer_load_dwordx4 v20, s[20:23], s46 offen  lds
    s_add_u32 m0, m0, 0x400
    s_nop 0
    buffer_load_dwordx4 v21, s[20:23], s46 offen  lds
    s_add_u32 m0, m0, 0x400
    s_add_u32 s46, s46, 98304
    s_mov_b32 m0, 86016
    s_add_u32 s46, s43, s47
    s_add_u32 s46, s46, 393216
    s_add_u32 s47, s47, 786432
    s_cmp_eq_u32 s47, 7864320
    s_cselect_b32 s47, 0, s47
    buffer_load_dwordx4 v19, s[20:23], s46 offen  lds
    s_add_u32 m0, m0, 0x400
    s_nop 0
    buffer_load_dwordx4 v20, s[20:23], s46 offen  lds
    s_add_u32 m0, m0, 0x400
    s_nop 0
    buffer_load_dwordx4 v21, s[20:23], s46 offen  lds
    s_add_u32 m0, m0, 0x400
    s_add_u32 s46, s46, 98304
    buffer_load_dwordx4 v19, s[20:23], s46 offen  lds
    s_add_u32 m0, m0, 0x400
    s_nop 0
    buffer_load_dwordx4 v20, s[20:23], s46 offen  lds
    s_add_u32 m0, m0, 0x400
    s_nop 0
    buffer_load_dwordx4 v21, s[20:23], s46 offen  lds
    s_add_u32 m0, m0, 0x400
    s_add_u32 s46, s46, 98304
    buffer_load_dwordx4 v19, s[20:23], s46 offen  lds
    s_add_u32 m0, m0, 0x400
    s_nop 0
    buffer_load_dwordx4 v20, s[20:23], s46 offen  lds
    s_add_u32 m0, m0, 0x400
    s_nop 0
    buffer_load_dwordx4 v21, s[20:23], s46 offen  lds
    s_add_u32 m0, m0, 0x400
    s_add_u32 s46, s46, 98304
    buffer_load_dwordx4 v19, s[20:23], s46 offen  lds
    s_add_u32 m0, m0, 0x400
    s_nop 0
    buffer_load_dwordx4 v20, s[20:23], s46 offen  lds
    s_add_u32 m0, m0, 0x400
    s_nop 0
    buffer_load_dwordx4 v21, s[20:23], s46 offen  lds
    s_add_u32 m0, m0, 0x400
    s_add_u32 s46, s46, 98304
    s_waitcnt vmcnt(24)
    s_waitcnt lgkmcnt(0)
    s_barrier
    s_mov_b32 m0, 0
    s_add_u32 s46, s43, s47
    buffer_load_dwordx4 v19, s[20:23], s46 offen  lds
    s_add_u32 m0, m0, 0x400
    s_nop 0
    buffer_load_dwordx4 v20, s[20:23], s46 offen  lds
    s_add_u32 m0, m0, 0x400
    s_nop 0
    buffer_load_dwordx4 v21, s[20:23], s46 offen  lds
    s_add_u32 m0, m0, 0x400
    s_add_u32 s46, s46, 98304
    buffer_load_dwordx4 v19, s[20:23], s46 offen  lds
    s_add_u32 m0, m0, 0x400
    s_nop 0
    buffer_load_dwordx4 v20, s[20:23], s46 offen  lds
    s_add_u32 m0, m0, 0x400
    s_nop 0
    buffer_load_dwordx4 v21, s[20:23], s46 offen  lds
    s_add_u32 m0, m0, 0x400
    s_add_u32 s46, s46, 98304
    buffer_load_dwordx4 v19, s[20:23], s46 offen  lds
    s_add_u32 m0, m0, 0x400
    s_nop 0
    buffer_load_dwordx4 v20, s[20:23], s46 offen  lds
    s_add_u32 m0, m0, 0x400
    s_nop 0
    buffer_load_dwordx4 v21, s[20:23], s46 offen  lds
    s_add_u32 m0, m0, 0x400
    s_add_u32 s46, s46, 98304
    buffer_load_dwordx4 v19, s[20:23], s46 offen  lds
    s_add_u32 m0, m0, 0x400
    s_nop 0
    buffer_load_dwordx4 v20, s[20:23], s46 offen  lds
    s_add_u32 m0, m0, 0x400
    s_nop 0
    buffer_load_dwordx4 v21, s[20:23], s46 offen  lds
    s_add_u32 m0, m0, 0x400
    s_add_u32 s46, s46, 98304
    s_mov_b32 m0, 12288
    s_add_u32 s46, s43, s47
    s_add_u32 s46, s46, 393216
    s_add_u32 s47, s47, 786432
    s_cmp_eq_u32 s47, 7864320
    s_cselect_b32 s47, 0, s47
    buffer_load_dwordx4 v19, s[20:23], s46 offen  lds
    s_add_u32 m0, m0, 0x400
    s_nop 0
    buffer_load_dwordx4 v20, s[20:23], s46 offen  lds
    s_add_u32 m0, m0, 0x400
    s_nop 0
    buffer_load_dwordx4 v21, s[20:23], s46 offen  lds
    s_add_u32 m0, m0, 0x400
    s_add_u32 s46, s46, 98304
    buffer_load_dwordx4 v19, s[20:23], s46 offen  lds
    s_add_u32 m0, m0, 0x400
    s_nop 0
    buffer_load_dwordx4 v20, s[20:23], s46 offen  lds
    s_add_u32 m0, m0, 0x400
    s_nop 0
    buffer_load_dwordx4 v21, s[20:23], s46 offen  lds
    s_add_u32 m0, m0, 0x400
    s_add_u32 s46, s46, 98304
    buffer_load_dwordx4 v19, s[20:23], s46 offen  lds
    s_add_u32 m0, m0, 0x400
    s_nop 0
    buffer_load_dwordx4 v20, s[20:23], s46 offen  lds
    s_add_u32 m0, m0, 0x400
    s_nop 0
    buffer_load_dwordx4 v21, s[20:23], s46 offen  lds
    s_add_u32 m0, m0, 0x400
    s_add_u32 s46, s46, 98304
    buffer_load_dwordx4 v19, s[20:23], s46 offen  lds
    s_add_u32 m0, m0, 0x400
    s_nop 0
    buffer_load_dwordx4 v20, s[20:23], s46 offen  lds
    s_add_u32 m0, m0, 0x400
    s_nop 0
    buffer_load_dwordx4 v21, s[20:23], s46 offen  lds
    s_add_u32 m0, m0, 0x400
    s_add_u32 s46, s46, 98304
    s_waitcnt vmcnt(24)
    s_waitcnt lgkmcnt(0)
    s_barrier
    s_mov_b32 m0, 24576
    s_add_u32 s46, s43, s47
    buffer_load_dwordx4 v19, s[20:23], s46 offen  lds
    s_add_u32 m0, m0, 0x400
    s_nop 0
    buffer_load_dwordx4 v20, s[20:23], s46 offen  lds
    s_add_u32 m0, m0, 0x400
    s_nop 0
    buffer_load_dwordx4 v21, s[20:23], s46 offen  lds
    s_add_u32 m0, m0, 0x400
    s_add_u32 s46, s46, 98304
    buffer_load_dwordx4 v19, s[20:23], s46 offen  lds
    s_add_u32 m0, m0, 0x400
    s_nop 0
    buffer_load_dwordx4 v20, s[20:23], s46 offen  lds
    s_add_u32 m0, m0, 0x400
    s_nop 0
    buffer_load_dwordx4 v21, s[20:23], s46 offen  lds
    s_add_u32 m0, m0, 0x400
    s_add_u32 s46, s46, 98304
    buffer_load_dwordx4 v19, s[20:23], s46 offen  lds
    s_add_u32 m0, m0, 0x400
    s_nop 0
    buffer_load_dwordx4 v20, s[20:23], s46 offen  lds
    s_add_u32 m0, m0, 0x400
    s_nop 0
    buffer_load_dwordx4 v21, s[20:23], s46 offen  lds
    s_add_u32 m0, m0, 0x400
    s_add_u32 s46, s46, 98304
    buffer_load_dwordx4 v19, s[20:23], s46 offen  lds
    s_add_u32 m0, m0, 0x400
    s_nop 0
    buffer_load_dwordx4 v20, s[20:23], s46 offen  lds
    s_add_u32 m0, m0, 0x400
    s_nop 0
    buffer_load_dwordx4 v21, s[20:23], s46 offen  lds
    s_add_u32 m0, m0, 0x400
    s_add_u32 s46, s46, 98304
    s_mov_b32 m0, 36864
    s_add_u32 s46, s43, s47
    s_add_u32 s46, s46, 393216
    s_add_u32 s47, s47, 786432
    s_cmp_eq_u32 s47, 7864320
    s_cselect_b32 s47, 0, s47
    buffer_load_dwordx4 v19, s[20:23], s46 offen  lds
    s_add_u32 m0, m0, 0x400
    s_nop 0
    buffer_load_dwordx4 v20, s[20:23], s46 offen  lds
    s_add_u32 m0, m0, 0x400
    s_nop 0
    buffer_load_dwordx4 v21, s[20:23], s46 offen  lds
    s_add_u32 m0, m0, 0x400
    s_add_u32 s46, s46, 98304
    buffer_load_dwordx4 v19, s[20:23], s46 offen  lds
    s_add_u32 m0, m0, 0x400
    s_nop 0
    buffer_load_dwordx4 v20, s[20:23], s46 offen  lds
    s_add_u32 m0, m0, 0x400
    s_nop 0
    buffer_load_dwordx4 v21, s[20:23], s46 offen  lds
    s_add_u32 m0, m0, 0x400
    s_add_u32 s46, s46, 98304
    buffer_load_dwordx4 v19, s[20:23], s46 offen  lds
    s_add_u32 m0, m0, 0x400
    s_nop 0
    buffer_load_dwordx4 v20, s[20:23], s46 offen  lds
    s_add_u32 m0, m0, 0x400
    s_nop 0
    buffer_load_dwordx4 v21, s[20:23], s46 offen  lds
    s_add_u32 m0, m0, 0x400
    s_add_u32 s46, s46, 98304
    buffer_load_dwordx4 v19, s[20:23], s46 offen  lds
    s_add_u32 m0, m0, 0x400
    s_nop 0
    buffer_load_dwordx4 v20, s[20:23], s46 offen  lds
    s_add_u32 m0, m0, 0x400
    s_nop 0
    buffer_load_dwordx4 v21, s[20:23], s46 offen  lds
    s_add_u32 m0, m0, 0x400
    s_add_u32 s46, s46, 98304
    s_waitcnt vmcnt(24)
    s_waitcnt lgkmcnt(0)
    s_barrier
    s_mov_b32 m0, 49152
    s_add_u32 s46, s43, s47
    buffer_load_dwordx4 v19, s[20:23], s46 offen  lds
    s_add_u32 m0, m0, 0x400
    s_nop 0
    buffer_load_dwordx4 v20, s[20:23], s46 offen  lds
    s_add_u32 m0, m0, 0x400
    s_nop 0
    buffer_load_dwordx4 v21, s[20:23], s46 offen  lds
    s_add_u32 m0, m0, 0x400
    s_add_u32 s46, s46, 98304
    buffer_load_dwordx4 v19, s[20:23], s46 offen  lds
    s_add_u32 m0, m0, 0x400
    s_nop 0
    buffer_load_dwordx4 v20, s[20:23], s46 offen  lds
    s_add_u32 m0, m0, 0x400
    s_nop 0
    buffer_load_dwordx4 v21, s[20:23], s46 offen  lds
    s_add_u32 m0, m0, 0x400
    s_add_u32 s46, s46, 98304
    buffer_load_dwordx4 v19, s[20:23], s46 offen  lds
    s_add_u32 m0, m0, 0x400
    s_nop 0
    buffer_load_dwordx4 v20, s[20:23], s46 offen  lds
    s_add_u32 m0, m0, 0x400
    s_nop 0
    buffer_load_dwordx4 v21, s[20:23], s46 offen  lds
    s_add_u32 m0, m0, 0x400
    s_add_u32 s46, s46, 98304
    buffer_load_dwordx4 v19, s[20:23], s46 offen  lds
    s_add_u32 m0, m0, 0x400
    s_nop 0
    buffer_load_dwordx4 v20, s[20:23], s46 offen  lds
    s_add_u32 m0, m0, 0x400
    s_nop 0
    buffer_load_dwordx4 v21, s[20:23], s46 offen  lds
    s_add_u32 m0, m0, 0x400
    s_add_u32 s46, s46, 98304
    s_mov_b32 m0, 61440
    s_add_u32 s46, s43, s47
    s_add_u32 s46, s46, 393216
    s_add_u32 s47, s47, 786432
    s_cmp_eq_u32 s47, 7864320
    s_cselect_b32 s47, 0, s47
    buffer_load_dwordx4 v19, s[20:23], s46 offen  lds
    s_add_u32 m0, m0, 0x400
    s_nop 0
    buffer_load_dwordx4 v20, s[20:23], s46 offen  lds
    s_add_u32 m0, m0, 0x400
    s_nop 0
    buffer_load_dwordx4 v21, s[20:23], s46 offen  lds
    s_add_u32 m0, m0, 0x400
    s_add_u32 s46, s46, 98304
    buffer_load_dwordx4 v19, s[20:23], s46 offen  lds
    s_add_u32 m0, m0, 0x400
    s_nop 0
    buffer_load_dwordx4 v20, s[20:23], s46 offen  lds
    s_add_u32 m0, m0, 0x400
    s_nop 0
    buffer_load_dwordx4 v21, s[20:23], s46 offen  lds
    s_add_u32 m0, m0, 0x400
    s_add_u32 s46, s46, 98304
    buffer_load_dwordx4 v19, s[20:23], s46 offen  lds
    s_add_u32 m0, m0, 0x400
    s_nop 0
    buffer_load_dwordx4 v20, s[20:23], s46 offen  lds
    s_add_u32 m0, m0, 0x400
    s_nop 0
    buffer_load_dwordx4 v21, s[20:23], s46 offen  lds
    s_add_u32 m0, m0, 0x400
    s_add_u32 s46, s46, 98304
    buffer_load_dwordx4 v19, s[20:23], s46 offen  lds
    s_add_u32 m0, m0, 0x400
    s_nop 0
    buffer_load_dwordx4 v20, s[20:23], s46 offen  lds
    s_add_u32 m0, m0, 0x400
    s_nop 0
    buffer_load_dwordx4 v21, s[20:23], s46 offen  lds
    s_add_u32 m0, m0, 0x400
    s_add_u32 s46, s46, 98304
    s_waitcnt vmcnt(24)
    s_waitcnt lgkmcnt(0)
    s_barrier
    s_mov_b32 m0, 73728
    s_add_u32 s46, s43, s47
    buffer_load_dwordx4 v19, s[20:23], s46 offen  lds
    s_add_u32 m0, m0, 0x400
    s_nop 0
    buffer_load_dwordx4 v20, s[20:23], s46 offen  lds
    s_add_u32 m0, m0, 0x400
    s_nop 0
    buffer_load_dwordx4 v21, s[20:23], s46 offen  lds
    s_add_u32 m0, m0, 0x400
    s_add_u32 s46, s46, 98304
    buffer_load_dwordx4 v19, s[20:23], s46 offen  lds
    s_add_u32 m0, m0, 0x400
    s_nop 0
    buffer_load_dwordx4 v20, s[20:23], s46 offen  lds
    s_add_u32 m0, m0, 0x400
    s_nop 0
    buffer_load_dwordx4 v21, s[20:23], s46 offen  lds
    s_add_u32 m0, m0, 0x400
    s_add_u32 s46, s46, 98304
    buffer_load_dwordx4 v19, s[20:23], s46 offen  lds
    s_add_u32 m0, m0, 0x400
    s_nop 0
    buffer_load_dwordx4 v20, s[20:23], s46 offen  lds
    s_add_u32 m0, m0, 0x400
    s_nop 0
    buffer_load_dwordx4 v21, s[20:23], s46 offen  lds
    s_add_u32 m0, m0, 0x400
    s_add_u32 s46, s46, 98304
    buffer_load_dwordx4 v19, s[20:23], s46 offen  lds
    s_add_u32 m0, m0, 0x400
    s_nop 0
    buffer_load_dwordx4 v20, s[20:23], s46 offen  lds
    s_add_u32 m0, m0, 0x400
    s_nop 0
    buffer_load_dwordx4 v21, s[20:23], s46 offen  lds
    s_add_u32 m0, m0, 0x400
    s_add_u32 s46, s46, 98304
    s_mov_b32 m0, 86016
    s_add_u32 s46, s43, s47
    s_add_u32 s46, s46, 393216
    s_add_u32 s47, s47, 786432
    s_cmp_eq_u32 s47, 7864320
    s_cselect_b32 s47, 0, s47
    buffer_load_dwordx4 v19, s[20:23], s46 offen  lds
    s_add_u32 m0, m0, 0x400
    s_nop 0
    buffer_load_dwordx4 v20, s[20:23], s46 offen  lds
    s_add_u32 m0, m0, 0x400
    s_nop 0
    buffer_load_dwordx4 v21, s[20:23], s46 offen  lds
    s_add_u32 m0, m0, 0x400
    s_add_u32 s46, s46, 98304
    buffer_load_dwordx4 v19, s[20:23], s46 offen  lds
    s_add_u32 m0, m0, 0x400
    s_nop 0
    buffer_load_dwordx4 v20, s[20:23], s46 offen  lds
    s_add_u32 m0, m0, 0x400
    s_nop 0
    buffer_load_dwordx4 v21, s[20:23], s46 offen  lds
    s_add_u32 m0, m0, 0x400
    s_add_u32 s46, s46, 98304
    buffer_load_dwordx4 v19, s[20:23], s46 offen  lds
    s_add_u32 m0, m0, 0x400
    s_nop 0
    buffer_load_dwordx4 v20, s[20:23], s46 offen  lds
    s_add_u32 m0, m0, 0x400
    s_nop 0
    buffer_load_dwordx4 v21, s[20:23], s46 offen  lds
    s_add_u32 m0, m0, 0x400
    s_add_u32 s46, s46, 98304
    buffer_load_dwordx4 v19, s[20:23], s46 offen  lds
    s_add_u32 m0, m0, 0x400
    s_nop 0
    buffer_load_dwordx4 v20, s[20:23], s46 offen  lds
    s_add_u32 m0, m0, 0x400
    s_nop 0
    buffer_load_dwordx4 v21, s[20:23], s46 offen  lds
    s_add_u32 m0, m0, 0x400
    s_add_u32 s46, s46, 98304
    s_waitcnt vmcnt(24)
    s_waitcnt lgkmcnt(0)
    s_barrier
    s_mov_b32 m0, 0
    s_add_u32 s46, s43, s47
    buffer_load_dwordx4 v19, s[20:23], s46 offen  lds
    s_add_u32 m0, m0, 0x400
    s_nop 0
    buffer_load_dwordx4 v20, s[20:23], s46 offen  lds
    s_add_u32 m0, m0, 0x400
    s_nop 0
    buffer_load_dwordx4 v21, s[20:23], s46 offen  lds
    s_add_u32 m0, m0, 0x400
    s_add_u32 s46, s46, 98304
    buffer_load_dwordx4 v19, s[20:23], s46 offen  lds
    s_add_u32 m0, m0, 0x400
    s_nop 0
    buffer_load_dwordx4 v20, s[20:23], s46 offen  lds
    s_add_u32 m0, m0, 0x400
    s_nop 0
    buffer_load_dwordx4 v21, s[20:23], s46 offen  lds
    s_add_u32 m0, m0, 0x400
    s_add_u32 s46, s46, 98304
    buffer_load_dwordx4 v19, s[20:23], s46 offen  lds
    s_add_u32 m0, m0, 0x400
    s_nop 0
    buffer_load_dwordx4 v20, s[20:23], s46 offen  lds
    s_add_u32 m0, m0, 0x400
    s_nop 0
    buffer_load_dwordx4 v21, s[20:23], s46 offen  lds
    s_add_u32 m0, m0, 0x400
    s_add_u32 s46, s46, 98304
    buffer_load_dwordx4 v19, s[20:23], s46 offen  lds
    s_add_u32 m0, m0, 0x400
    s_nop 0
    buffer_load_dwordx4 v20, s[20:23], s46 offen  lds
    s_add_u32 m0, m0, 0x400
    s_nop 0
    buffer_load_dwordx4 v21, s[20:23], s46 offen  lds
    s_add_u32 m0, m0, 0x400
    s_add_u32 s46, s46, 98304
    s_mov_b32 m0, 12288
    s_add_u32 s46, s43, s47
    s_add_u32 s46, s46, 393216
    s_add_u32 s47, s47, 786432
    s_cmp_eq_u32 s47, 7864320
    s_cselect_b32 s47, 0, s47
    buffer_load_dwordx4 v19, s[20:23], s46 offen  lds
    s_add_u32 m0, m0, 0x400
    s_nop 0
    buffer_load_dwordx4 v20, s[20:23], s46 offen  lds
    s_add_u32 m0, m0, 0x400
    s_nop 0
    buffer_load_dwordx4 v21, s[20:23], s46 offen  lds
    s_add_u32 m0, m0, 0x400
    s_add_u32 s46, s46, 98304
    buffer_load_dwordx4 v19, s[20:23], s46 offen  lds
    s_add_u32 m0, m0, 0x400
    s_nop 0
    buffer_load_dwordx4 v20, s[20:23], s46 offen  lds
    s_add_u32 m0, m0, 0x400
    s_nop 0
    buffer_load_dwordx4 v21, s[20:23], s46 offen  lds
    s_add_u32 m0, m0, 0x400
    s_add_u32 s46, s46, 98304
    buffer_load_dwordx4 v19, s[20:23], s46 offen  lds
    s_add_u32 m0, m0, 0x400
    s_nop 0
    buffer_load_dwordx4 v20, s[20:23], s46 offen  lds
    s_add_u32 m0, m0, 0x400
    s_nop 0
    buffer_load_dwordx4 v21, s[20:23], s46 offen  lds
    s_add_u32 m0, m0, 0x400
    s_add_u32 s46, s46, 98304
    buffer_load_dwordx4 v19, s[20:23], s46 offen  lds
    s_add_u32 m0, m0, 0x400
    s_nop 0
    buffer_load_dwordx4 v20, s[20:23], s46 offen  lds
    s_add_u32 m0, m0, 0x400
    s_nop 0
    buffer_load_dwordx4 v21, s[20:23], s46 offen  lds
    s_add_u32 m0, m0, 0x400
    s_add_u32 s46, s46, 98304
    s_waitcnt vmcnt(24)
    s_waitcnt lgkmcnt(0)
    s_barrier
    s_mov_b32 m0, 24576
    s_add_u32 s46, s43, s47
    buffer_load_dwordx4 v19, s[20:23], s46 offen  lds
    s_add_u32 m0, m0, 0x400
    s_nop 0
    buffer_load_dwordx4 v20, s[20:23], s46 offen  lds
    s_add_u32 m0, m0, 0x400
    s_nop 0
    buffer_load_dwordx4 v21, s[20:23], s46 offen  lds
    s_add_u32 m0, m0, 0x400
    s_add_u32 s46, s46, 98304
    buffer_load_dwordx4 v19, s[20:23], s46 offen  lds
    s_add_u32 m0, m0, 0x400
    s_nop 0
    buffer_load_dwordx4 v20, s[20:23], s46 offen  lds
    s_add_u32 m0, m0, 0x400
    s_nop 0
    buffer_load_dwordx4 v21, s[20:23], s46 offen  lds
    s_add_u32 m0, m0, 0x400
    s_add_u32 s46, s46, 98304
    buffer_load_dwordx4 v19, s[20:23], s46 offen  lds
    s_add_u32 m0, m0, 0x400
    s_nop 0
    buffer_load_dwordx4 v20, s[20:23], s46 offen  lds
    s_add_u32 m0, m0, 0x400
    s_nop 0
    buffer_load_dwordx4 v21, s[20:23], s46 offen  lds
    s_add_u32 m0, m0, 0x400
    s_add_u32 s46, s46, 98304
    buffer_load_dwordx4 v19, s[20:23], s46 offen  lds
    s_add_u32 m0, m0, 0x400
    s_nop 0
    buffer_load_dwordx4 v20, s[20:23], s46 offen  lds
    s_add_u32 m0, m0, 0x400
    s_nop 0
    buffer_load_dwordx4 v21, s[20:23], s46 offen  lds
    s_add_u32 m0, m0, 0x400
    s_add_u32 s46, s46, 98304
    s_mov_b32 m0, 36864
    s_add_u32 s46, s43, s47
    s_add_u32 s46, s46, 393216
    s_add_u32 s47, s47, 786432
    s_cmp_eq_u32 s47, 7864320
    s_cselect_b32 s47, 0, s47
    buffer_load_dwordx4 v19, s[20:23], s46 offen  lds
    s_add_u32 m0, m0, 0x400
    s_nop 0
    buffer_load_dwordx4 v20, s[20:23], s46 offen  lds
    s_add_u32 m0, m0, 0x400
    s_nop 0
    buffer_load_dwordx4 v21, s[20:23], s46 offen  lds
    s_add_u32 m0, m0, 0x400
    s_add_u32 s46, s46, 98304
    buffer_load_dwordx4 v19, s[20:23], s46 offen  lds
    s_add_u32 m0, m0, 0x400
    s_nop 0
    buffer_load_dwordx4 v20, s[20:23], s46 offen  lds
    s_add_u32 m0, m0, 0x400
    s_nop 0
    buffer_load_dwordx4 v21, s[20:23], s46 offen  lds
    s_add_u32 m0, m0, 0x400
    s_add_u32 s46, s46, 98304
    buffer_load_dwordx4 v19, s[20:23], s46 offen  lds
    s_add_u32 m0, m0, 0x400
    s_nop 0
    buffer_load_dwordx4 v20, s[20:23], s46 offen  lds
    s_add_u32 m0, m0, 0x400
    s_nop 0
    buffer_load_dwordx4 v21, s[20:23], s46 offen  lds
    s_add_u32 m0, m0, 0x400
    s_add_u32 s46, s46, 98304
    buffer_load_dwordx4 v19, s[20:23], s46 offen  lds
    s_add_u32 m0, m0, 0x400
    s_nop 0
    buffer_load_dwordx4 v20, s[20:23], s46 offen  lds
    s_add_u32 m0, m0, 0x400
    s_nop 0
    buffer_load_dwordx4 v21, s[20:23], s46 offen  lds
    s_add_u32 m0, m0, 0x400
    s_add_u32 s46, s46, 98304
    s_waitcnt vmcnt(24)
    s_waitcnt lgkmcnt(0)
    s_barrier
    s_waitcnt vmcnt(0)
    s_waitcnt lgkmcnt(0)
    s_barrier
    s_waitcnt lgkmcnt(0)
    s_barrier
    s_waitcnt lgkmcnt(0)
    s_barrier
    s_mov_b32 m0, 49152
    s_add_u32 s46, s41, 36864
    buffer_load_dwordx4 v10, s[12:15], s46 offen nt lds
    s_add_u32 m0, m0, 0x400
    s_nop 0
    buffer_load_dwordx4 v11, s[12:15], s46 offen nt lds
    s_add_u32 m0, m0, 0x400
    s_nop 0
    buffer_load_dwordx4 v12, s[12:15], s46 offen nt lds
    s_add_u32 m0, m0, 0x400
    s_nop 0
    buffer_load_dwordx4 v13, s[12:15], s46 offen nt lds
    s_add_u32 m0, m0, 0x400
    s_nop 0
    buffer_load_dwordx4 v14, s[12:15], s46 offen nt lds
    s_add_u32 m0, m0, 0x400
    s_nop 0
    buffer_load_dwordx4 v15, s[12:15], s46 offen nt lds
    s_add_u32 m0, m0, 0x400
    s_add_u32 s46, s46, 6144
    buffer_load_dwordx4 v10, s[12:15], s46 offen nt lds
    s_add_u32 m0, m0, 0x400
    s_nop 0
    buffer_load_dwordx4 v11, s[12:15], s46 offen nt lds
    s_add_u32 m0, m0, 0x400
    s_nop 0
    buffer_load_dwordx4 v12, s[12:15], s46 offen nt lds
    s_add_u32 m0, m0, 0x400
    s_nop 0
    buffer_load_dwordx4 v13, s[12:15], s46 offen nt lds
    s_add_u32 m0, m0, 0x400
    s_nop 0
    buffer_load_dwordx4 v14, s[12:15], s46 offen nt lds
    s_add_u32 m0, m0, 0x400
    s_nop 0
    buffer_load_dwordx4 v15, s[12:15], s46 offen nt lds
    s_add_u32 m0, m0, 0x400
    s_add_u32 s46, s46, 6144
    s_mov_b32 m0, 98304
    s_add_u32 s46, s42, 36864
    buffer_load_dwordx4 v10, s[12:15], s46 offen nt lds
    s_add_u32 m0, m0, 0x400
    s_nop 0
    buffer_load_dwordx4 v11, s[12:15], s46 offen nt lds
    s_add_u32 m0, m0, 0x400
    s_nop 0
    buffer_load_dwordx4 v12, s[12:15], s46 offen nt lds
    s_add_u32 m0, m0, 0x400
    s_nop 0
    buffer_load_dwordx4 v13, s[12:15], s46 offen nt lds
    s_add_u32 m0, m0, 0x400
    s_nop 0
    buffer_load_dwordx4 v14, s[12:15], s46 offen nt lds
    s_add_u32 m0, m0, 0x400
    s_nop 0
    buffer_load_dwordx4 v15, s[12:15], s46 offen nt lds
    s_add_u32 m0, m0, 0x400
    s_add_u32 s46, s46, 6144
    buffer_load_dwordx4 v10, s[12:15], s46 offen nt lds
    s_add_u32 m0, m0, 0x400
    s_nop 0
    buffer_load_dwordx4 v11, s[12:15], s46 offen nt lds
    s_add_u32 m0, m0, 0x400
    s_nop 0
    buffer_load_dwordx4 v12, s[12:15], s46 offen nt lds
    s_add_u32 m0, m0, 0x400
    s_nop 0
    buffer_load_dwordx4 v13, s[12:15], s46 offen nt lds
    s_add_u32 m0, m0, 0x400
    s_nop 0
    buffer_load_dwordx4 v14, s[12:15], s46 offen nt lds
    s_add_u32 m0, m0, 0x400
    s_nop 0
    buffer_load_dwordx4 v15, s[12:15], s46 offen nt lds
    s_add_u32 m0, m0, 0x400
    s_add_u32 s46, s46, 6144
    s_waitcnt lgkmcnt(0)
    s_barrier
    s_mov_b32 m0, 73728
    s_add_u32 s46, s41, 49152
    buffer_load_dwordx4 v10, s[12:15], s46 offen nt lds
    s_add_u32 m0, m0, 0x400
    s_nop 0
    buffer_load_dwordx4 v11, s[12:15], s46 offen nt lds
    s_add_u32 m0, m0, 0x400
    s_nop 0
    buffer_load_dwordx4 v12, s[12:15], s46 offen nt lds
    s_add_u32 m0, m0, 0x400
    s_nop 0
    buffer_load_dwordx4 v13, s[12:15], s46 offen nt lds
    s_add_u32 m0, m0, 0x400
    s_nop 0
    buffer_load_dwordx4 v14, s[12:15], s46 offen nt lds
    s_add_u32 m0, m0, 0x400
    s_nop 0
    buffer_load_dwordx4 v15, s[12:15], s46 offen nt lds
    s_add_u32 m0, m0, 0x400
    s_add_u32 s46, s46, 6144
    buffer_load_dwordx4 v10, s[12:15], s46 offen nt lds
    s_add_u32 m0, m0, 0x400
    s_nop 0
    buffer_load_dwordx4 v11, s[12:15], s46 offen nt lds
    s_add_u32 m0, m0, 0x400
    s_nop 0
    buffer_load_dwordx4 v12, s[12:15], s46 offen nt lds
    s_add_u32 m0, m0, 0x400
    s_nop 0
    buffer_load_dwordx4 v13, s[12:15], s46 offen nt lds
    s_add_u32 m0, m0, 0x400
    s_nop 0
    buffer_load_dwordx4 v14, s[12:15], s46 offen nt lds
    s_add_u32 m0, m0, 0x400
    s_nop 0
    buffer_load_dwordx4 v15, s[12:15], s46 offen nt lds
    s_add_u32 m0, m0, 0x400
    s_add_u32 s46, s46, 6144
    s_mov_b32 m0, 122880
    s_add_u32 s46, s42, 49152
    buffer_load_dwordx4 v10, s[12:15], s46 offen nt lds
    s_add_u32 m0, m0, 0x400
    s_nop 0
    buffer_load_dwordx4 v11, s[12:15], s46 offen nt lds
    s_add_u32 m0, m0, 0x400
    s_nop 0
    buffer_load_dwordx4 v12, s[12:15], s46 offen nt lds
    s_add_u32 m0, m0, 0x400
    s_nop 0
    buffer_load_dwordx4 v13, s[12:15], s46 offen nt lds
    s_add_u32 m0, m0, 0x400
    s_nop 0
    buffer_load_dwordx4 v14, s[12:15], s46 offen nt lds
    s_add_u32 m0, m0, 0x400
    s_nop 0
    buffer_load_dwordx4 v15, s[12:15], s46 offen nt lds
    s_add_u32 m0, m0, 0x400
    s_add_u32 s46, s46, 6144
    buffer_load_dwordx4 v10, s[12:15], s46 offen nt lds
    s_add_u32 m0, m0, 0x400
    s_nop 0
    buffer_load_dwordx4 v11, s[12:15], s46 offen nt lds
    s_add_u32 m0, m0, 0x400
    s_nop 0
    buffer_load_dwordx4 v12, s[12:15], s46 offen nt lds
    s_add_u32 m0, m0, 0x400
    s_nop 0
    buffer_load_dwordx4 v13, s[12:15], s46 offen nt lds
    s_add_u32 m0, m0, 0x400
    s_nop 0
    buffer_load_dwordx4 v14, s[12:15], s46 offen nt lds
    s_add_u32 m0, m0, 0x400
    s_nop 0
    buffer_load_dwordx4 v15, s[12:15], s46 offen nt lds
    s_add_u32 m0, m0, 0x400
    s_add_u32 s46, s46, 6144
    s_mov_b32 s72, 0
    s_mov_b32 s76, 24576
    s_mov_b32 s73, 49152
    s_mov_b32 s77, 98304
    s_mov_b32 s74, 73728
    s_mov_b32 s78, 122880
    s_mov_b32 s75, 61440
    s_mov_b32 s79, 27
L1_ldloop0:
    s_waitcnt vmcnt(24)
    s_barrier
    s_mov_b32 m0, s72
    s_add_u32 s46, s41, s75
    buffer_load_dwordx4 v10, s[12:15], s46 offen nt lds
    s_add_u32 m0, m0, 0x400
    s_nop 0
    buffer_load_dwordx4 v11, s[12:15], s46 offen nt lds
    s_add_u32 m0, m0, 0x400
    s_nop 0
    buffer_load_dwordx4 v12, s[12:15], s46 offen nt lds
    s_add_u32 m0, m0, 0x400
    s_nop 0
    buffer_load_dwordx4 v13, s[12:15], s46 offen nt lds
    s_add_u32 m0, m0, 0x400
    s_nop 0
    buffer_load_dwordx4 v14, s[12:15], s46 offen nt lds
    s_add_u32 m0, m0, 0x400
    s_nop 0
    buffer_load_dwordx4 v15, s[12:15], s46 offen nt lds
    s_add_u32 m0, m0, 0x400
    s_add_u32 s46, s46, 6144
    buffer_load_dwordx4 v10, s[12:15], s46 offen nt lds
    s_add_u32 m0, m0, 0x400
    s_nop 0
    buffer_load_dwordx4 v11, s[12:15], s46 offen nt lds
    s_add_u32 m0, m0, 0x400
    s_nop 0
    buffer_load_dwordx4 v12, s[12:15], s46 offen nt lds
    s_add_u32 m0, m0, 0x400
    s_nop 0
    buffer_load_dwordx4 v13, s[12:15], s46 offen nt lds
    s_add_u32 m0, m0, 0x400
    s_nop 0
    buffer_load_dwordx4 v14, s[12:15], s46 offen nt lds
    s_add_u32 m0, m0, 0x400
    s_nop 0
    buffer_load_dwordx4 v15, s[12:15], s46 offen nt lds
    s_add_u32 m0, m0, 0x400
    s_add_u32 s46, s46, 6144
    s_mov_b32 s46, s72
    s_mov_b32 s72, s73
    s_mov_b32 s73, s74
    s_mov_b32 s74, s46
    s_mov_b32 m0, s76
    s_add_u32 s46, s42, s75
    buffer_load_dwordx4 v10, s[12:15], s46 offen nt lds
    s_add_u32 m0, m0, 0x400
    s_nop 0
    buffer_load_dwordx4 v11, s[12:15], s46 offen nt lds
    s_add_u32 m0, m0, 0x400
    s_nop 0
    buffer_load_dwordx4 v12, s[12:15], s46 offen nt lds
    s_add_u32 m0, m0, 0x400
    s_nop 0
    buffer_load_dwordx4 v13, s[12:15], s46 offen nt lds
    s_add_u32 m0, m0, 0x400
    s_nop 0
    buffer_load_dwordx4 v14, s[12:15], s46 offen nt lds
    s_add_u32 m0, m0, 0x400
    s_nop 0
    buffer_load_dwordx4 v15, s[12:15], s46 offen nt lds
    s_add_u32 m0, m0, 0x400
    s_add_u32 s46, s46, 6144
    buffer_load_dwordx4 v10, s[12:15], s46 offen nt lds
    s_add_u32 m0, m0, 0x400
    s_nop 0
    buffer_load_dwordx4 v11, s[12:15], s46 offen nt lds
    s_add_u32 m0, m0, 0x400
    s_nop 0
    buffer_load_dwordx4 v12, s[12:15], s46 offen nt lds
    s_add_u32 m0, m0, 0x400
    s_nop 0
    buffer_load_dwordx4 v13, s[12:15], s46 offen nt lds
    s_add_u32 m0, m0, 0x400
    s_nop 0
    buffer_load_dwordx4 v14, s[12:15], s46 offen nt lds
    s_add_u32 m0, m0, 0x400
    s_nop 0
    buffer_load_dwordx4 v15, s[12:15], s46 offen nt lds
    s_add_u32 m0, m0, 0x400
    s_add_u32 s46, s46, 6144
    s_mov_b32 s46, s76
    s_mov_b32 s76, s77
    s_mov_b32 s77, s78
    s_mov_b32 s78, s46
    s_add_u32 s75, s75, 12288
    s_sub_u32 s79, s79, 1
    s_cmp_lg_u32 s79, 0
    s_cbranch_scc1 L1_ldloop0
    s_waitcnt vmcnt(24)
    s_waitcnt lgkmcnt(0)
    s_barrier
    s_waitcnt vmcnt(0)
    s_waitcnt lgkmcnt(0)
    s_barrier
    s_endpgm
L1_loader1:
    s_mov_b32 m0, 12288
    s_add_u32 s46, s43, s47
    s_add_u32 s46, s46, 393216
    s_add_u32 s47, s47, 786432
    s_cmp_eq_u32 s47, 7864320
    s_cselect_b32 s47, 0, s47
    buffer_load_dwordx4 v19, s[20:23], s46 offen  lds
    s_add_u32 m0, m0, 0x400
    s_nop 0
    buffer_load_dwordx4 v20, s[20:23], s46 offen  lds
    s_add_u32 m0, m0, 0x400
    s_nop 0
    buffer_load_dwordx4 v21, s[20:23], s46 offen  lds
    s_add_u32 m0, m0, 0x400
    s_add_u32 s46, s46, 98304
    buffer_load_dwordx4 v19, s[20:23], s46 offen  lds
    s_add_u32 m0, m0, 0x400
    s_nop 0
    buffer_load_dwordx4 v20, s[20:23], s46 offen  lds
    s_add_u32 m0, m0, 0x400
    s_nop 0
    buffer_load_dwordx4 v21, s[20:23], s46 offen  lds
    s_add_u32 m0, m0, 0x400
    s_add_u32 s46, s46, 98304
    buffer_load_dwordx4 v19, s[20:23], s46 offen  lds
    s_add_u32 m0, m0, 0x400
    s_nop 0
    buffer_load_dwordx4 v20, s[20:23], s46 offen  lds
    s_add_u32 m0, m0, 0x400
    s_nop 0
    buffer_load_dwordx4 v21, s[20:23], s46 offen  lds
    s_add_u32 m0, m0, 0x400
    s_add_u32 s46, s46, 98304
    buffer_load_dwordx4 v19, s[20:23], s46 offen  lds
    s_add_u32 m0, m0, 0x400
    s_nop 0
    buffer_load_dwordx4 v20, s[20:23], s46 offen  lds
    s_add_u32 m0, m0, 0x400
    s_nop 0
    buffer_load_dwordx4 v21, s[20:23], s46 offen  lds
    s_add_u32 m0, m0, 0x400
    s_add_u32 s46, s46, 98304
    s_mov_b32 m0, 36864
    s_add_u32 s46, s43, s47
    s_add_u32 s46, s46, 393216
    s_add_u32 s47, s47, 786432
    s_cmp_eq_u32 s47, 7864320
    s_cselect_b32 s47, 0, s47
    buffer_load_dwordx4 v19, s[20:23], s46 offen  lds
    s_add_u32 m0, m0, 0x400
    s_nop 0
    buffer_load_dwordx4 v20, s[20:23], s46 offen  lds
    s_add_u32 m0, m0, 0x400
    s_nop 0
    buffer_load_dwordx4 v21, s[20:23], s46 offen  lds
    s_add_u32 m0, m0, 0x400
    s_add_u32 s46, s46, 98304
    buffer_load_dwordx4 v19, s[20:23], s46 offen  lds
    s_add_u32 m0, m0, 0x400
    s_nop 0
    buffer_load_dwordx4 v20, s[20:23], s46 offen  lds
    s_add_u32 m0, m0, 0x400
    s_nop 0
    buffer_load_dwordx4 v21, s[20:23], s46 offen  lds
    s_add_u32 m0, m0, 0x400
    s_add_u32 s46, s46, 98304
    buffer_load_dwordx4 v19, s[20:23], s46 offen  lds
    s_add_u32 m0, m0, 0x400
    s_nop 0
    buffer_load_dwordx4 v20, s[20:23], s46 offen  lds
    s_add_u32 m0, m0, 0x400
    s_nop 0
    buffer_load_dwordx4 v21, s[20:23], s46 offen  lds
    s_add_u32 m0, m0, 0x400
    s_add_u32 s46, s46, 98304
    buffer_load_dwordx4 v19, s[20:23], s46 offen  lds
    s_add_u32 m0, m0, 0x400
    s_nop 0
    buffer_load_dwordx4 v20, s[20:23], s46 offen  lds
    s_add_u32 m0, m0, 0x400
    s_nop 0
    buffer_load_dwordx4 v21, s[20:23], s46 offen  lds
    s_add_u32 m0, m0, 0x400
    s_add_u32 s46, s46, 98304
    s_waitcnt vmcnt(12)
    s_waitcnt lgkmcnt(0)
    s_barrier
    s_waitcnt vmcnt(0)
    s_waitcnt lgkmcnt(0)
    s_barrier
    s_waitcnt lgkmcnt(0)
    s_barrier
    s_waitcnt lgkmcnt(0)
    s_barrier
    s_waitcnt lgkmcnt(0)
    s_barrier
    s_waitcnt lgkmcnt(0)
    s_barrier
    s_mov_b32 m0, 98304
    s_add_u32 s46, s42, 0
    buffer_load_dwordx4 v10, s[12:15], s46 offen nt lds
    s_add_u32 m0, m0, 0x400
    s_nop 0
    buffer_load_dwordx4 v11, s[12:15], s46 offen nt lds
    s_add_u32 m0, m0, 0x400
    s_nop 0
    buffer_load_dwordx4 v12, s[12:15], s46 offen nt lds
    s_add_u32 m0, m0, 0x400
    s_nop 0
    buffer_load_dwordx4 v13, s[12:15], s46 offen nt lds
    s_add_u32 m0, m0, 0x400
    s_nop 0
    buffer_load_dwordx4 v14, s[12:15], s46 offen nt lds
    s_add_u32 m0, m0, 0x400
    s_nop 0
    buffer_load_dwordx4 v15, s[12:15], s46 offen nt lds
    s_add_u32 m0, m0, 0x400
    s_add_u32 s46, s46, 6144
    buffer_load_dwordx4 v10, s[12:15], s46 offen nt lds
    s_add_u32 m0, m0, 0x400
    s_nop 0
    buffer_load_dwordx4 v11, s[12:15], s46 offen nt lds
    s_add_u32 m0, m0, 0x400
    s_nop 0
    buffer_load_dwordx4 v12, s[12:15], s46 offen nt lds
    s_add_u32 m0, m0, 0x400
    s_nop 0
    buffer_load_dwordx4 v13, s[12:15], s46 offen nt lds
    s_add_u32 m0, m0, 0x400
    s_nop 0
    buffer_load_dwordx4 v14, s[12:15], s46 offen nt lds
    s_add_u32 m0, m0, 0x400
    s_nop 0
    buffer_load_dwordx4 v15, s[12:15], s46 offen nt lds
    s_add_u32 m0, m0, 0x400
    s_add_u32 s46, s46, 6144
    s_mov_b32 m0, 110592
    s_add_u32 s46, s42, 0
    buffer_load_dwordx4 v16, s[16:19], s46 offen nt lds
    s_add_u32 m0, m0, 0x400
    s_nop 0
    buffer_load_dwordx4 v17, s[16:19], s46 offen nt lds
    s_add_u32 m0, m0, 0x400
    s_nop 0
    buffer_load_dwordx4 v18, s[16:19], s46 offen nt lds
    s_add_u32 m0, m0, 0x400
    s_add_u32 s46, s46, 3072
    buffer_load_dwordx4 v16, s[16:19], s46 offen nt lds
    s_add_u32 m0, m0, 0x400
    s_nop 0
    buffer_load_dwordx4 v17, s[16:19], s46 offen nt lds
    s_add_u32 m0, m0, 0x400
    s_nop 0
    buffer_load_dwordx4 v18, s[16:19], s46 offen nt lds
    s_add_u32 m0, m0, 0x400
    s_add_u32 s46, s46, 3072
    buffer_load_dwordx4 v16, s[16:19], s46 offen nt lds
    s_add_u32 m0, m0, 0x400
    s_nop 0
    buffer_load_dwordx4 v17, s[16:19], s46 offen nt lds
    s_add_u32 m0, m0, 0x400
    s_nop 0
    buffer_load_dwordx4 v18, s[16:19], s46 offen nt lds
    s_add_u32 m0, m0, 0x400
    s_add_u32 s46, s46, 3072
    buffer_load_dwordx4 v16, s[16:19], s46 offen nt lds
    s_add_u32 m0, m0, 0x400
    s_nop 0
    buffer_load_dwordx4 v17, s[16:19], s46 offen nt lds
    s_add_u32 m0, m0, 0x400
    s_nop 0
    buffer_load_dwordx4 v18, s[16:19], s46 offen nt lds
    s_add_u32 m0, m0, 0x400
    s_add_u32 s46, s46, 3072
    s_waitcnt lgkmcnt(0)
    s_barrier
    s_mov_b32 m0, 122880
    s_add_u32 s46, s42, 12288
    buffer_load_dwordx4 v10, s[12:15], s46 offen nt lds
    s_add_u32 m0, m0, 0x400
    s_nop 0
    buffer_load_dwordx4 v11, s[12:15], s46 offen nt lds
    s_add_u32 m0, m0, 0x400
    s_nop 0
    buffer_load_dwordx4 v12, s[12:15], s46 offen nt lds
    s_add_u32 m0, m0, 0x400
    s_nop 0
    buffer_load_dwordx4 v13, s[12:15], s46 offen nt lds
    s_add_u32 m0, m0, 0x400
    s_nop 0
    buffer_load_dwordx4 v14, s[12:15], s46 offen nt lds
    s_add_u32 m0, m0, 0x400
    s_nop 0
    buffer_load_dwordx4 v15, s[12:15], s46 offen nt lds
    s_add_u32 m0, m0, 0x400
    s_add_u32 s46, s46, 6144
    buffer_load_dwordx4 v10, s[12:15], s46 offen nt lds
    s_add_u32 m0, m0, 0x400
    s_nop 0
    buffer_load_dwordx4 v11, s[12:15], s46 offen nt lds
    s_add_u32 m0, m0, 0x400
    s_nop 0
    buffer_load_dwordx4 v12, s[12:15], s46 offen nt lds
    s_add_u32 m0, m0, 0x400
    s_nop 0
    buffer_load_dwordx4 v13, s[12:15], s46 offen nt lds
    s_add_u32 m0, m0, 0x400
    s_nop 0
    buffer_load_dwordx4 v14, s[12:15], s46 offen nt lds
    s_add_u32 m0, m0, 0x400
    s_nop 0
    buffer_load_dwordx4 v15, s[12:15], s46 offen nt lds
    s_add_u32 m0, m0, 0x400
    s_add_u32 s46, s46, 6144
    s_mov_b32 m0, 135168
    s_add_u32 s46, s42, 12288
    buffer_load_dwordx4 v16, s[16:19], s46 offen nt lds
    s_add_u32 m0, m0, 0x400
    s_nop 0
    buffer_load_dwordx4 v17, s[16:19], s46 offen nt lds
    s_add_u32 m0, m0, 0x400
    s_nop 0
    buffer_load_dwordx4 v18, s[16:19], s46 offen nt lds
    s_add_u32 m0, m0, 0x400
    s_add_u32 s46, s46, 3072
    buffer_load_dwordx4 v16, s[16:19], s46 offen nt lds
    s_add_u32 m0, m0, 0x400
    s_nop 0
    buffer_load_dwordx4 v17, s[16:19], s46 offen nt lds
    s_add_u32 m0, m0, 0x400
    s_nop 0
    buffer_load_dwordx4 v18, s[16:19], s46 offen nt lds
    s_add_u32 m0, m0, 0x400
    s_add_u32 s46, s46, 3072
    buffer_load_dwordx4 v16, s[16:19], s46 offen nt lds
    s_add_u32 m0, m0, 0x400
    s_nop 0
    buffer_load_dwordx4 v17, s[16:19], s46 offen nt lds
    s_add_u32 m0, m0, 0x400
    s_nop 0
    buffer_load_dwordx4 v18, s[16:19], s46 offen nt lds
    s_add_u32 m0, m0, 0x400
    s_add_u32 s46, s46, 3072
    buffer_load_dwordx4 v16, s[16:19], s46 offen nt lds
    s_add_u32 m0, m0, 0x400
    s_nop 0
    buffer_load_dwordx4 v17, s[16:19], s46 offen nt lds
    s_add_u32 m0, m0, 0x400
    s_nop 0
    buffer_load_dwordx4 v18, s[16:19], s46 offen nt lds
    s_add_u32 m0, m0, 0x400
    s_add_u32 s46, s46, 3072
    s_waitcnt lgkmcnt(0)
    s_barrier
    s_mov_b32 m0, 49152
    s_add_u32 s46, s41, 0
    buffer_load_dwordx4 v10, s[12:15], s46 offen nt lds
    s_add_u32 m0, m0, 0x400
    s_nop 0
    buffer_load_dwordx4 v11, s[12:15], s46 offen nt lds
    s_add_u32 m0, m0, 0x400
    s_nop 0
    buffer_load_dwordx4 v12, s[12:15], s46 offen nt lds
    s_add_u32 m0, m0, 0x400
    s_nop 0
    buffer_load_dwordx4 v13, s[12:15], s46 offen nt lds
    s_add_u32 m0, m0, 0x400
    s_nop 0
    buffer_load_dwordx4 v14, s[12:15], s46 offen nt lds
    s_add_u32 m0, m0, 0x400
    s_nop 0
    buffer_load_dwordx4 v15, s[12:15], s46 offen nt lds
    s_add_u32 m0, m0, 0x400
    s_add_u32 s46, s46, 6144
    buffer_load_dwordx4 v10, s[12:15], s46 offen nt lds
    s_add_u32 m0, m0, 0x400
    s_nop 0
    buffer_load_dwordx4 v11, s[12:15], s46 offen nt lds
    s_add_u32 m0, m0, 0x400
    s_nop 0
    buffer_load_dwordx4 v12, s[12:15], s46 offen nt lds
    s_add_u32 m0, m0, 0x400
    s_nop 0
    buffer_load_dwordx4 v13, s[12:15], s46 offen nt lds
    s_add_u32 m0, m0, 0x400
    s_nop 0
    buffer_load_dwordx4 v14, s[12:15], s46 offen nt lds
    s_add_u32 m0, m0, 0x400
    s_nop 0
    buffer_load_dwordx4 v15, s[12:15], s46 offen nt lds
    s_add_u32 m0, m0, 0x400
    s_add_u32 s46, s46, 6144
    s_waitcnt vmcnt(48)
    s_mov_b32 m0, 61440
    s_add_u32 s46, s41, 0
    buffer_load_dwordx4 v16, s[16:19], s46 offen nt lds
    s_add_u32 m0, m0, 0x400
    s_nop 0
    buffer_load_dwordx4 v17, s[16:19], s46 offen nt lds
    s_add_u32 m0, m0, 0x400
    s_nop 0
    buffer_load_dwordx4 v18, s[16:19], s46 offen nt lds
    s_add_u32 m0, m0, 0x400
    s_add_u32 s46, s46, 3072
    buffer_load_dwordx4 v16, s[16:19], s46 offen nt lds
    s_add_u32 m0, m0, 0x400
    s_nop 0
    buffer_load_dwordx4 v17, s[16:19], s46 offen nt lds
    s_add_u32 m0, m0, 0x400
    s_nop 0
    buffer_load_dwordx4 v18, s[16:19], s46 offen nt lds
    s_add_u32 m0, m0, 0x400
    s_add_u32 s46, s46, 3072
    buffer_load_dwordx4 v16, s[16:19], s46 offen nt lds
    s_add_u32 m0, m0, 0x400
    s_nop 0
    buffer_load_dwordx4 v17, s[16:19], s46 offen nt lds
    s_add_u32 m0, m0, 0x400
    s_nop 0
    buffer_load_dwordx4 v18, s[16:19], s46 offen nt lds
    s_add_u32 m0, m0, 0x400
    s_add_u32 s46, s46, 3072
    buffer_load_dwordx4 v16, s[16:19], s46 offen nt lds
    s_add_u32 m0, m0, 0x400
    s_nop 0
    buffer_load_dwordx4 v17, s[16:19], s46 offen nt lds
    s_add_u32 m0, m0, 0x400
    s_nop 0
    buffer_load_dwordx4 v18, s[16:19], s46 offen nt lds
    s_add_u32 m0, m0, 0x400
    s_add_u32 s46, s46, 3072
    s_waitcnt lgkmcnt(0)
    s_barrier
    s_waitcnt vmcnt(48)
    s_mov_b32 m0, 73728
    s_add_u32 s46, s41, 12288
    buffer_load_dwordx4 v10, s[12:15], s46 offen nt lds
    s_add_u32 m0, m0, 0x400
    s_nop 0
    buffer_load_dwordx4 v11, s[12:15], s46 offen nt lds
    s_add_u32 m0, m0, 0x400
    s_nop 0
    buffer_load_dwordx4 v12, s[12:15], s46 offen nt lds
    s_add_u32 m0, m0, 0x400
    s_nop 0
    buffer_load_dwordx4 v13, s[12:15], s46 offen nt lds
    s_add_u32 m0, m0, 0x400
    s_nop 0
    buffer_load_dwordx4 v14, s[12:15], s46 offen nt lds
    s_add_u32 m0, m0, 0x400
    s_nop 0
    buffer_load_dwordx4 v15, s[12:15], s46 offen nt lds
    s_add_u32 m0, m0, 0x400
    s_add_u32 s46, s46, 6144
    buffer_load_dwordx4 v10, s[12:15], s46 offen nt lds
    s_add_u32 m0, m0, 0x400
    s_nop 0
    buffer_load_dwordx4 v11, s[12:15], s46 offen nt lds
    s_add_u32 m0, m0, 0x400
    s_nop 0
    buffer_load_dwordx4 v12, s[12:15], s46 offen nt lds
    s_add_u32 m0, m0, 0x400
    s_nop 0
    buffer_load_dwordx4 v13, s[12:15], s46 offen nt lds
    s_add_u32 m0, m0, 0x400
    s_nop 0
    buffer_load_dwordx4 v14, s[12:15], s46 offen nt lds
    s_add_u32 m0, m0, 0x400
    s_nop 0
    buffer_load_dwordx4 v15, s[12:15], s46 offen nt lds
    s_add_u32 m0, m0, 0x400
    s_add_u32 s46, s46, 6144
    s_waitcnt vmcnt(48)
    s_mov_b32 m0, 86016
    s_add_u32 s46, s41, 12288
    buffer_load_dwordx4 v16, s[16:19], s46 offen nt lds
    s_add_u32 m0, m0, 0x400
    s_nop 0
    buffer_load_dwordx4 v17, s[16:19], s46 offen nt lds
    s_add_u32 m0, m0, 0x400
    s_nop 0
    buffer_load_dwordx4 v18, s[16:19], s46 offen nt lds
    s_add_u32 m0, m0, 0x400
    s_add_u32 s46, s46, 3072
    buffer_load_dwordx4 v16, s[16:19], s46 offen nt lds
    s_add_u32 m0, m0, 0x400
    s_nop 0
    buffer_load_dwordx4 v17, s[16:19], s46 offen nt lds
    s_add_u32 m0, m0, 0x400
    s_nop 0
    buffer_load_dwordx4 v18, s[16:19], s46 offen nt lds
    s_add_u32 m0, m0, 0x400
    s_add_u32 s46, s46, 3072
    buffer_load_dwordx4 v16, s[16:19], s46 offen nt lds
    s_add_u32 m0, m0, 0x400
    s_nop 0
    buffer_load_dwordx4 v17, s[16:19], s46 offen nt lds
    s_add_u32 m0, m0, 0x400
    s_nop 0
    buffer_load_dwordx4 v18, s[16:19], s46 offen nt lds
    s_add_u32 m0, m0, 0x400
    s_add_u32 s46, s46, 3072
    buffer_load_dwordx4 v16, s[16:19], s46 offen nt lds
    s_add_u32 m0, m0, 0x400
    s_nop 0
    buffer_load_dwordx4 v17, s[16:19], s46 offen nt lds
    s_add_u32 m0, m0, 0x400
    s_nop 0
    buffer_load_dwordx4 v18, s[16:19], s46 offen nt lds
    s_add_u32 m0, m0, 0x400
    s_add_u32 s46, s46, 3072
    s_waitcnt lgkmcnt(0)
    s_barrier
    s_waitcnt vmcnt(48)
    s_mov_b32 m0, 0
    s_add_u32 s46, s41, 24576
    buffer_load_dwordx4 v10, s[12:15], s46 offen nt lds
    s_add_u32 m0, m0, 0x400
    s_nop 0
    buffer_load_dwordx4 v11, s[12:15], s46 offen nt lds
    s_add_u32 m0, m0, 0x400
    s_nop 0
    buffer_load_dwordx4 v12, s[12:15], s46 offen nt lds
    s_add_u32 m0, m0, 0x400
    s_nop 0
    buffer_load_dwordx4 v13, s[12:15], s46 offen nt lds
    s_add_u32 m0, m0, 0x400
    s_nop 0
    buffer_load_dwordx4 v14, s[12:15], s46 offen nt lds
    s_add_u32 m0, m0, 0x400
    s_nop 0
    buffer_load_dwordx4 v15, s[12:15], s46 offen nt lds
    s_add_u32 m0, m0, 0x400
    s_add_u32 s46, s46, 6144
    buffer_load_dwordx4 v10, s[12:15], s46 offen nt lds
    s_add_u32 m0, m0, 0x400
    s_nop 0
    buffer_load_dwordx4 v11, s[12:15], s46 offen nt lds
    s_add_u32 m0, m0, 0x400
    s_nop 0
    buffer_load_dwordx4 v12, s[12:15], s46 offen nt lds
    s_add_u32 m0, m0, 0x400
    s_nop 0
    buffer_load_dwordx4 v13, s[12:15], s46 offen nt lds
    s_add_u32 m0, m0, 0x400
    s_nop 0
    buffer_load_dwordx4 v14, s[12:15], s46 offen nt lds
    s_add_u32 m0, m0, 0x400
    s_nop 0
    buffer_load_dwordx4 v15, s[12:15], s46 offen nt lds
    s_add_u32 m0, m0, 0x400
    s_add_u32 s46, s46, 6144
    s_waitcnt vmcnt(48)
    s_mov_b32 m0, 12288
    s_add_u32 s46, s41, 24576
    buffer_load_dwordx4 v16, s[16:19], s46 offen nt lds
    s_add_u32 m0, m0, 0x400
    s_nop 0
    buffer_load_dwordx4 v17, s[16:19], s46 offen nt lds
    s_add_u32 m0, m0, 0x400
    s_nop 0
    buffer_load_dwordx4 v18, s[16:19], s46 offen nt lds
    s_add_u32 m0, m0, 0x400
    s_add_u32 s46, s46, 3072
    buffer_load_dwordx4 v16, s[16:19], s46 offen nt lds
    s_add_u32 m0, m0, 0x400
    s_nop 0
    buffer_load_dwordx4 v17, s[16:19], s46 offen nt lds
    s_add_u32 m0, m0, 0x400
    s_nop 0
    buffer_load_dwordx4 v18, s[16:19], s46 offen nt lds
    s_add_u32 m0, m0, 0x400
    s_add_u32 s46, s46, 3072
    buffer_load_dwordx4 v16, s[16:19], s46 offen nt lds
    s_add_u32 m0, m0, 0x400
    s_nop 0
    buffer_load_dwordx4 v17, s[16:19], s46 offen nt lds
    s_add_u32 m0, m0, 0x400
    s_nop 0
    buffer_load_dwordx4 v18, s[16:19], s46 offen nt lds
    s_add_u32 m0, m0, 0x400
    s_add_u32 s46, s46, 3072
    buffer_load_dwordx4 v16, s[16:19], s46 offen nt lds
    s_add_u32 m0, m0, 0x400
    s_nop 0
    buffer_load_dwordx4 v17, s[16:19], s46 offen nt lds
    s_add_u32 m0, m0, 0x400
    s_nop 0
    buffer_load_dwordx4 v18, s[16:19], s46 offen nt lds
    s_add_u32 m0, m0, 0x400
    s_add_u32 s46, s46, 3072
    s_waitcnt vmcnt(48)
    s_waitcnt lgkmcnt(0)
    s_barrier
    s_mov_b32 m0, 24576
    s_add_u32 s46, s42, 24576
    buffer_load_dwordx4 v10, s[12:15], s46 offen nt lds
    s_add_u32 m0, m0, 0x400
    s_nop 0
    buffer_load_dwordx4 v11, s[12:15], s46 offen nt lds
    s_add_u32 m0, m0, 0x400
    s_nop 0
    buffer_load_dwordx4 v12, s[12:15], s46 offen nt lds
    s_add_u32 m0, m0, 0x400
    s_nop 0
    buffer_load_dwordx4 v13, s[12:15], s46 offen nt lds
    s_add_u32 m0, m0, 0x400
    s_nop 0
    buffer_load_dwordx4 v14, s[12:15], s46 offen nt lds
    s_add_u32 m0, m0, 0x400
    s_nop 0
    buffer_load_dwordx4 v15, s[12:15], s46 offen nt lds
    s_add_u32 m0, m0, 0x400
    s_add_u32 s46, s46, 6144
    buffer_load_dwordx4 v10, s[12:15], s46 offen nt lds
    s_add_u32 m0, m0, 0x400
    s_nop 0
    buffer_load_dwordx4 v11, s[12:15], s46 offen nt lds
    s_add_u32 m0, m0, 0x400
    s_nop 0
    buffer_load_dwordx4 v12, s[12:15], s46 offen nt lds
    s_add_u32 m0, m0, 0x400
    s_nop 0
    buffer_load_dwordx4 v13, s[12:15], s46 offen nt lds
    s_add_u32 m0, m0, 0x400
    s_nop 0
    buffer_load_dwordx4 v14, s[12:15], s46 offen nt lds
    s_add_u32 m0, m0, 0x400
    s_nop 0
    buffer_load_dwordx4 v15, s[12:15], s46 offen nt lds
    s_add_u32 m0, m0, 0x400
    s_add_u32 s46, s46, 6144
    s_waitcnt vmcnt(48)
    s_mov_b32 m0, 36864
    s_add_u32 s46, s42, 24576
    buffer_load_dwordx4 v16, s[16:19], s46 offen nt lds
    s_add_u32 m0, m0, 0x400
    s_nop 0
    buffer_load_dwordx4 v17, s[16:19], s46 offen nt lds
    s_add_u32 m0, m0, 0x400
    s_nop 0
    buffer_load_dwordx4 v18, s[16:19], s46 offen nt lds
    s_add_u32 m0, m0, 0x400
    s_add_u32 s46, s46, 3072
    buffer_load_dwordx4 v16, s[16:19], s46 offen nt lds
    s_add_u32 m0, m0, 0x400
    s_nop 0
    buffer_load_dwordx4 v17, s[16:19], s46 offen nt lds
    s_add_u32 m0, m0, 0x400
    s_nop 0
    buffer_load_dwordx4 v18, s[16:19], s46 offen nt lds
    s_add_u32 m0, m0, 0x400
    s_add_u32 s46, s46, 3072
    buffer_load_dwordx4 v16, s[16:19], s46 offen nt lds
    s_add_u32 m0, m0, 0x400
    s_nop 0
    buffer_load_dwordx4 v17, s[16:19], s46 offen nt lds
    s_add_u32 m0, m0, 0x400
    s_nop 0
    buffer_load_dwordx4 v18, s[16:19], s46 offen nt lds
    s_add_u32 m0, m0, 0x400
    s_add_u32 s46, s46, 3072
    buffer_load_dwordx4 v16, s[16:19], s46 offen nt lds
    s_add_u32 m0, m0, 0x400
    s_nop 0
    buffer_load_dwordx4 v17, s[16:19], s46 offen nt lds
    s_add_u32 m0, m0, 0x400
    s_nop 0
    buffer_load_dwordx4 v18, s[16:19], s46 offen nt lds
    s_add_u32 m0, m0, 0x400
    s_add_u32 s46, s46, 3072
    s_waitcnt vmcnt(48)
    s_waitcnt lgkmcnt(0)
    s_barrier
    s_mov_b32 m0, 61440
    s_add_u32 s46, s41, 36864
    buffer_load_dwordx4 v16, s[16:19], s46 offen nt lds
    s_add_u32 m0, m0, 0x400
    s_nop 0
    buffer_load_dwordx4 v17, s[16:19], s46 offen nt lds
    s_add_u32 m0, m0, 0x400
    s_nop 0
    buffer_load_dwordx4 v18, s[16:19], s46 offen nt lds
    s_add_u32 m0, m0, 0x400
    s_add_u32 s46, s46, 3072
    buffer_load_dwordx4 v16, s[16:19], s46 offen nt lds
    s_add_u32 m0, m0, 0x400
    s_nop 0
    buffer_load_dwordx4 v17, s[16:19], s46 offen nt lds
    s_add_u32 m0, m0, 0x400
    s_nop 0
    buffer_load_dwordx4 v18, s[16:19], s46 offen nt lds
    s_add_u32 m0, m0, 0x400
    s_add_u32 s46, s46, 3072
    buffer_load_dwordx4 v16, s[16:19], s46 offen nt lds
    s_add_u32 m0, m0, 0x400
    s_nop 0
    buffer_load_dwordx4 v17, s[16:19], s46 offen nt lds
    s_add_u32 m0, m0, 0x400
    s_nop 0
    buffer_load_dwordx4 v18, s[16:19], s46 offen nt lds
    s_add_u32 m0, m0, 0x400
    s_add_u32 s46, s46, 3072
    buffer_load_dwordx4 v16, s[16:19], s46 offen nt lds
    s_add_u32 m0, m0, 0x400
    s_nop 0
    buffer_load_dwordx4 v17, s[16:19], s46 offen nt lds
    s_add_u32 m0, m0, 0x400
    s_nop 0
    buffer_load_dwordx4 v18, s[16:19], s46 offen nt lds
    s_add_u32 m0, m0, 0x400
    s_add_u32 s46, s46, 3072
    s_waitcnt vmcnt(48)
    s_mov_b32 m0, 110592
    s_add_u32 s46, s42, 36864
    buffer_load_dwordx4 v16, s[16:19], s46 offen nt lds
    s_add_u32 m0, m0, 0x400
    s_nop 0
    buffer_load_dwordx4 v17, s[16:19], s46 offen nt lds
    s_add_u32 m0, m0, 0x400
    s_nop 0
    buffer_load_dwordx4 v18, s[16:19], s46 offen nt lds
    s_add_u32 m0, m0, 0x400
    s_add_u32 s46, s46, 3072
    buffer_load_dwordx4 v16, s[16:19], s46 offen nt lds
    s_add_u32 m0, m0, 0x400
    s_nop 0
    buffer_load_dwordx4 v17, s[16:19], s46 offen nt lds
    s_add_u32 m0, m0, 0x400
    s_nop 0
    buffer_load_dwordx4 v18, s[16:19], s46 offen nt lds
    s_add_u32 m0, m0, 0x400
    s_add_u32 s46, s46, 3072
    buffer_load_dwordx4 v16, s[16:19], s46 offen nt lds
    s_add_u32 m0, m0, 0x400
    s_nop 0
    buffer_load_dwordx4 v17, s[16:19], s46 offen nt lds
    s_add_u32 m0, m0, 0x400
    s_nop 0
    buffer_load_dwordx4 v18, s[16:19], s46 offen nt lds
    s_add_u32 m0, m0, 0x400
    s_add_u32 s46, s46, 3072
    buffer_load_dwordx4 v16, s[16:19], s46 offen nt lds
    s_add_u32 m0, m0, 0x400
    s_nop 0
    buffer_load_dwordx4 v17, s[16:19], s46 offen nt lds
    s_add_u32 m0, m0, 0x400
    s_nop 0
    buffer_load_dwordx4 v18, s[16:19], s46 offen nt lds
    s_add_u32 m0, m0, 0x400
    s_add_u32 s46, s46, 3072
    s_waitcnt vmcnt(24)
    s_waitcnt lgkmcnt(0)
    s_barrier
    s_mov_b32 m0, 86016
    s_add_u32 s46, s41, 49152
    buffer_load_dwordx4 v16, s[16:19], s46 offen nt lds
    s_add_u32 m0, m0, 0x400
    s_nop 0
    buffer_load_dwordx4 v17, s[16:19], s46 offen nt lds
    s_add_u32 m0, m0, 0x400
    s_nop 0
    buffer_load_dwordx4 v18, s[16:19], s46 offen nt lds
    s_add_u32 m0, m0, 0x400
    s_add_u32 s46, s46, 3072
    buffer_load_dwordx4 v16, s[16:19], s46 offen nt lds
    s_add_u32 m0, m0, 0x400
    s_nop 0
    buffer_load_dwordx4 v17, s[16:19], s46 offen nt lds
    s_add_u32 m0, m0, 0x400
    s_nop 0
    buffer_load_dwordx4 v18, s[16:19], s46 offen nt lds
    s_add_u32 m0, m0, 0x400
    s_add_u32 s46, s46, 3072
    buffer_load_dwordx4 v16, s[16:19], s46 offen nt lds
    s_add_u32 m0, m0, 0x400
    s_nop 0
    buffer_load_dwordx4 v17, s[16:19], s46 offen nt lds
    s_add_u32 m0, m0, 0x400
    s_nop 0
    buffer_load_dwordx4 v18, s[16:19], s46 offen nt lds
    s_add_u32 m0, m0, 0x400
    s_add_u32 s46, s46, 3072
    buffer_load_dwordx4 v16, s[16:19], s46 offen nt lds
    s_add_u32 m0, m0, 0x400
    s_nop 0
    buffer_load_dwordx4 v17, s[16:19], s46 offen nt lds
    s_add_u32 m0, m0, 0x400
    s_nop 0
    buffer_load_dwordx4 v18, s[16:19], s46 offen nt lds
    s_add_u32 m0, m0, 0x400
    s_add_u32 s46, s46, 3072
    s_mov_b32 m0, 135168
    s_add_u32 s46, s42, 49152
    buffer_load_dwordx4 v16, s[16:19], s46 offen nt lds
    s_add_u32 m0, m0, 0x400
    s_nop 0
    buffer_load_dwordx4 v17, s[16:19], s46 offen nt lds
    s_add_u32 m0, m0, 0x400
    s_nop 0
    buffer_load_dwordx4 v18, s[16:19], s46 offen nt lds
    s_add_u32 m0, m0, 0x400
    s_add_u32 s46, s46, 3072
    buffer_load_dwordx4 v16, s[16:19], s46 offen nt lds
    s_add_u32 m0, m0, 0x400
    s_nop 0
    buffer_load_dwordx4 v17, s[16:19], s46 offen nt lds
    s_add_u32 m0, m0, 0x400
    s_nop 0
    buffer_load_dwordx4 v18, s[16:19], s46 offen nt lds
    s_add_u32 m0, m0, 0x400
    s_add_u32 s46, s46, 3072
    buffer_load_dwordx4 v16, s[16:19], s46 offen nt lds
    s_add_u32 m0, m0, 0x400
    s_nop 0
    buffer_load_dwordx4 v17, s[16:19], s46 offen nt lds
    s_add_u32 m0, m0, 0x400
    s_nop 0
    buffer_load_dwordx4 v18, s[16:19], s46 offen nt lds
    s_add_u32 m0, m0, 0x400
    s_add_u32 s46, s46, 3072
    buffer_load_dwordx4 v16, s[16:19], s46 offen nt lds
    s_add_u32 m0, m0, 0x400
    s_nop 0
    buffer_load_dwordx4 v17, s[16:19], s46 offen nt lds
    s_add_u32 m0, m0, 0x400
    s_nop 0
    buffer_load_dwordx4 v18, s[16:19], s46 offen nt lds
    s_add_u32 m0, m0, 0x400
    s_add_u32 s46, s46, 3072
    s_mov_b32 s72, 12288
    s_mov_b32 s76, 36864
    s_mov_b32 s73, 61440
    s_mov_b32 s77, 110592
    s_mov_b32 s74, 86016
    s_mov_b32 s78, 135168
    s_mov_b32 s75, 61440
    s_mov_b32 s79, 27
L1_ldloop1:
    s_waitcnt vmcnt(24)
    s_barrier
    s_mov_b32 m0, s72
    s_add_u32 s46, s41, s75
    buffer_load_dwordx4 v16, s[16:19], s46 offen nt lds
    s_add_u32 m0, m0, 0x400
    s_nop 0
    buffer_load_dwordx4 v17, s[16:19], s46 offen nt lds
    s_add_u32 m0, m0, 0x400
    s_nop 0
    buffer_load_dwordx4 v18, s[16:19], s46 offen nt lds
    s_add_u32 m0, m0, 0x400
    s_add_u32 s46, s46, 3072
    buffer_load_dwordx4 v16, s[16:19], s46 offen nt lds
    s_add_u32 m0, m0, 0x400
    s_nop 0
    buffer_load_dwordx4 v17, s[16:19], s46 offen nt lds
    s_add_u32 m0, m0, 0x400
    s_nop 0
    buffer_load_dwordx4 v18, s[16:19], s46 offen nt lds
    s_add_u32 m0, m0, 0x400
    s_add_u32 s46, s46, 3072
    buffer_load_dwordx4 v16, s[16:19], s46 offen nt lds
    s_add_u32 m0, m0, 0x400
    s_nop 0
    buffer_load_dwordx4 v17, s[16:19], s46 offen nt lds
    s_add_u32 m0, m0, 0x400
    s_nop 0
    buffer_load_dwordx4 v18, s[16:19], s46 offen nt lds
    s_add_u32 m0, m0, 0x400
    s_add_u32 s46, s46, 3072
    buffer_load_dwordx4 v16, s[16:19], s46 offen nt lds
    s_add_u32 m0, m0, 0x400
    s_nop 0
    buffer_load_dwordx4 v17, s[16:19], s46 offen nt lds
    s_add_u32 m0, m0, 0x400
    s_nop 0
    buffer_load_dwordx4 v18, s[16:19], s46 offen nt lds
    s_add_u32 m0, m0, 0x400
    s_add_u32 s46, s46, 3072
    s_mov_b32 s46, s72
    s_mov_b32 s72, s73
    s_mov_b32 s73, s74
    s_mov_b32 s74, s46
    s_mov_b32 m0, s76
    s_add_u32 s46, s42, s75
    buffer_load_dwordx4 v16, s[16:19], s46 offen nt lds
    s_add_u32 m0, m0, 0x400
    s_nop 0
    buffer_load_dwordx4 v17, s[16:19], s46 offen nt lds
    s_add_u32 m0, m0, 0x400
    s_nop 0
    buffer_load_dwordx4 v18, s[16:19], s46 offen nt lds
    s_add_u32 m0, m0, 0x400
    s_add_u32 s46, s46, 3072
    buffer_load_dwordx4 v16, s[16:19], s46 offen nt lds
    s_add_u32 m0, m0, 0x400
    s_nop 0
    buffer_load_dwordx4 v17, s[16:19], s46 offen nt lds
    s_add_u32 m0, m0, 0x400
    s_nop 0
    buffer_load_dwordx4 v18, s[16:19], s46 offen nt lds
    s_add_u32 m0, m0, 0x400
    s_add_u32 s46, s46, 3072
    buffer_load_dwordx4 v16, s[16:19], s46 offen nt lds
    s_add_u32 m0, m0, 0x400
    s_nop 0
    buffer_load_dwordx4 v17, s[16:19], s46 offen nt lds
    s_add_u32 m0, m0, 0x400
    s_nop 0
    buffer_load_dwordx4 v18, s[16:19], s46 offen nt lds
    s_add_u32 m0, m0, 0x400
    s_add_u32 s46, s46, 3072
    buffer_load_dwordx4 v16, s[16:19], s46 offen nt lds
    s_add_u32 m0, m0, 0x400
    s_nop 0
    buffer_load_dwordx4 v17, s[16:19], s46 offen nt lds
    s_add_u32 m0, m0, 0x400
    s_nop 0
    buffer_load_dwordx4 v18, s[16:19], s46 offen nt lds
    s_add_u32 m0, m0, 0x400
    s_add_u32 s46, s46, 3072
    s_mov_b32 s46, s76
    s_mov_b32 s76, s77
    s_mov_b32 s77, s78
    s_mov_b32 s78, s46
    s_add_u32 s75, s75, 12288
    s_sub_u32 s79, s79, 1
    s_cmp_lg_u32 s79, 0
    s_cbranch_scc1 L1_ldloop1
    s_waitcnt vmcnt(24)
    s_waitcnt lgkmcnt(0)
    s_barrier
    v_lshlrev_b32 v24, 7, v2
    s_mul_i32 s46, s2, 30720
    buffer_load_dword v25, v24, s[96:99], s46 offen
    s_add_u32 s46, s46, 8192
    buffer_load_dword v26, v24, s[96:99], s46 offen
    s_add_u32 s46, s46, 8192
    buffer_load_dword v27, v24, s[96:99], s46 offen
    s_add_u32 s46, s46, 8192
    buffer_load_dword v28, v24, s[96:99], s46 offen
    s_add_u32 s46, s46, 8192
    s_waitcnt vmcnt(0)
    s_waitcnt lgkmcnt(0)
    s_barrier
    s_endpgm
L1_compute:
    v_and_b32 v3, 15, v2
    v_lshrrev_b32 v4, 5, v2
    v_and_b32 v5, 31, v2
    v_lshrrev_b32 v6, 4, v2
    v_and_b32 v6, 1, v6
    v_lshrrev_b32 v7, 2, v3
    v_and_b32 v8, 3, v3
    v_lshlrev_b32 v8, 3, v8
    v_lshl_add_u32 v8, v6, 5, v8
    v_lshrrev_b32 v9, 3, v3
    v_lshlrev_b32 v9, 6, v9
    v_lshl_add_u32 v14, v4, 3, v7
    v_mul_u32_u24 v14, 0x180, v14
    v_add_u32 v14, v14, v8
    v_add_u32 v10, v14, v9
    v_xor_b32 v15, 64, v9
    v_add_u32 v11, v14, v15
    v_lshl_add_u32 v14, v4, 2, v7
    v_mul_u32_u24 v14, 0x180, v14
    v_add_u32 v14, v14, v8
    v_add_u32 v12, v14, v9
    v_add_u32 v13, v14, v15
    v_lshrrev_b32 v14, 1, v5
    v_and_b32 v14, 7, v14
    v_mul_u32_u24 v15, 0x180, v5
    v_add_u32 v9, 0, v4
    v_xor_b32 v9, v9, v14
    v_lshl_add_u32 v232, v9, 4, v15
    v_add_u32 v9, 2, v4
    v_xor_b32 v9, v9, v14
    v_lshl_add_u32 v233, v9, 4, v15
    v_add_u32 v9, 4, v4
    v_xor_b32 v9, v9, v14
    v_lshl_add_u32 v234, v9, 4, v15
    v_add_u32 v9, 6, v4
    v_xor_b32 v9, v9, v14
    v_lshl_add_u32 v235, v9, 4, v15
    s_lshl_b32 s45, s3, 3
    s_add_u32 s45, s45, s38
    s_mul_i32 s45, s45, 96
    s_lshl_b32 s46, s40, 5
    s_add_u32 s45, s45, s46
    v_add_u32 v14, s45, v5
    v_lshlrev_b32 v15, 4, v4
    v_mul_u32_u24 v250, 0x500, v14
    v_add_u32 v250, v250, v15
    s_lshr_b32 s46, s45, 5
    s_mul_i32 s46, s46, 384
    s_mul_i32 s47, s39, 12
    s_add_u32 s46, s46, s47
    s_lshl_b32 s46, s46, 10
    v_lshlrev_b32 v251, 4, v2
    v_add_u32 v251, s46, v251
    v_mov_b32 v242, 0xff800000
    v_mov_b32 v243, 0
    s_mov_b32 s49, 0x3dd53b95
    s_cmp_eq_u32 s3, 0
    s_mov_b32 s47, 98304
    s_cselect_b32 s47, 49152, s47
    s_mov_b32 s52, 122880
    s_cselect_b32 s52, 73728, s52
    s_mov_b32 s53, 24576
    s_cselect_b32 s53, 0, s53
    s_lshl_b32 s54, s55, 7
    buffer_load_dwordx4 v[16:19], v250, s[8:11], s54 offen offset:0
    buffer_load_dwordx4 v[20:23], v250, s[8:11], s54 offen offset:32
    buffer_load_dwordx4 v[24:27], v250, s[8:11], s54 offen offset:64
    buffer_load_dwordx4 v[28:31], v250, s[8:11], s54 offen offset:96
    s_add_u32 s54, s54, 128
    s_cmp_eq_u32 s54, 1280
    s_cselect_b32 s54, 0, s54
    buffer_load_dwordx4 v[32:35], v250, s[8:11], s54 offen offset:0
    buffer_load_dwordx4 v[36:39], v250, s[8:11], s54 offen offset:32
    buffer_load_dwordx4 v[40:43], v250, s[8:11], s54 offen offset:64
    buffer_load_dwordx4 v[44:47], v250, s[8:11], s54 offen offset:96
    s_add_u32 s54, s54, 128
    s_cmp_eq_u32 s54, 1280
    s_cselect_b32 s54, 0, s54
    buffer_load_dwordx4 v[48:51], v250, s[8:11], s54 offen offset:0
    buffer_load_dwordx4 v[52:55], v250, s[8:11], s54 offen offset:32
    buffer_load_dwordx4 v[56:59], v250, s[8:11], s54 offen offset:64
    buffer_load_dwordx4 v[60:63], v250, s[8:11], s54 offen offset:96
    s_add_u32 s54, s54, 128
    s_cmp_eq_u32 s54, 1280
    s_cselect_b32 s54, 0, s54
    s_barrier
    v_add_u32 v236, 0, v10
    v_add_u32 v237, 0, v11
    buffer_load_dwordx4 v[160:163], v250, s[8:11], s54 offen offset:0
    buffer_load_dwordx4 v[164:167], v250, s[8:11], s54 offen offset:32
    buffer_load_dwordx4 v[168:171], v250, s[8:11], s54 offen offset:64
    buffer_load_dwordx4 v[172:175], v250, s[8:11], s54 offen offset:96
    s_add_u32 s54, s54, 128
    s_cmp_eq_u32 s54, 1280
    s_cselect_b32 s54, 0, s54
    s_waitcnt vmcnt(12)
    ds_read_b64_tr_b16 v[184:185], v236 offset:0
    ds_read_b64_tr_b16 v[186:187], v236 offset:1536
    ds_read_b64_tr_b16 v[188:189], v237 offset:0
    ds_read_b64_tr_b16 v[190:191], v237 offset:1536
    ds_read_b64_tr_b16 v[192:193], v236 offset:128
    ds_read_b64_tr_b16 v[194:195], v236 offset:1664
    ds_read_b64_tr_b16 v[196:197], v237 offset:128
    ds_read_b64_tr_b16 v[198:199], v237 offset:1664
    ds_read_b64_tr_b16 v[200:201], v236 offset:256
    ds_read_b64_tr_b16 v[202:203], v236 offset:1792
    ds_read_b64_tr_b16 v[204:205], v237 offset:256
    ds_read_b64_tr_b16 v[206:207], v237 offset:1792
    ds_read_b64_tr_b16 v[208:209], v236 offset:6144
    ds_read_b64_tr_b16 v[210:211], v236 offset:7680
    s_waitcnt lgkmcnt(12)
    v_mfma_f32_32x32x16_bf16 v[64:79], v[184:187], v[16:19], 0
    ds_read_b64_tr_b16 v[212:213], v237 offset:6144
    ds_read_b64_tr_b16 v[214:215], v237 offset:7680
    s_waitcnt lgkmcnt(12)
    v_mfma_f32_32x32x16_bf16 v[80:95], v[188:191], v[16:19], 0
    ds_read_b64_tr_b16 v[216:217], v236 offset:6272
    ds_read_b64_tr_b16 v[218:219], v236 offset:7808
    s_waitcnt lgkmcnt(12)
    v_mfma_f32_32x32x16_bf16 v[96:111], v[192:195], v[16:19], 0
    ds_read_b64_tr_b16 v[220:221], v237 offset:6272
    ds_read_b64_tr_b16 v[222:223], v237 offset:7808
    s_waitcnt lgkmcnt(12)
    v_mfma_f32_32x32x16_bf16 v[112:127], v[196:199], v[16:19], 0
    ds_read_b64_tr_b16 v[224:225], v236 offset:6400
    ds_read_b64_tr_b16 v[226:227], v236 offset:7936
    s_waitcnt lgkmcnt(12)
    v_mfma_f32_32x32x16_bf16 v[128:143], v[200:203], v[16:19], 0
    ds_read_b64_tr_b16 v[228:229], v237 offset:6400
    ds_read_b64_tr_b16 v[230:231], v237 offset:7936
    s_waitcnt lgkmcnt(12)
    v_mfma_f32_32x32x16_bf16 v[144:159], v[204:207], v[16:19], 0
    ds_read_b64_tr_b16 v[184:185], v236 offset:12288
    ds_read_b64_tr_b16 v[186:187], v236 offset:13824
    s_waitcnt lgkmcnt(12)
    v_mfma_f32_32x32x16_bf16 v[64:79], v[208:211], v[20:23], v[64:79]
    ds_read_b64_tr_b16 v[188:189], v237 offset:12288
    ds_read_b64_tr_b16 v[190:191], v237 offset:13824
    s_waitcnt lgkmcnt(12)
    v_mfma_f32_32x32x16_bf16 v[80:95], v[212:215], v[20:23], v[80:95]
    ds_read_b64_tr_b16 v[192:193], v236 offset:12416
    ds_read_b64_tr_b16 v[194:195], v236 offset:13952
    s_waitcnt lgkmcnt(12)
    v_mfma_f32_32x32x16_bf16 v[96:111], v[216:219], v[20:23], v[96:111]
    ds_read_b64_tr_b16 v[196:197], v237 offset:12416
    ds_read_b64_tr_b16 v[198:199], v237 offset:13952
    s_waitcnt lgkmcnt(12)
    v_mfma_f32_32x32x16_bf16 v[112:127], v[220:223], v[20:23], v[112:127]
    ds_read_b64_tr_b16 v[200:201], v236 offset:12544
    ds_read_b64_tr_b16 v[202:203], v236 offset:14080
    s_waitcnt lgkmcnt(12)
    v_mfma_f32_32x32x16_bf16 v[128:143], v[224:227], v[20:23], v[128:143]
    ds_read_b64_tr_b16 v[204:205], v237 offset:12544
    ds_read_b64_tr_b16 v[206:207], v237 offset:14080
    s_waitcnt lgkmcnt(12)
    v_mfma_f32_32x32x16_bf16 v[144:159], v[228:231], v[20:23], v[144:159]
    ds_read_b64_tr_b16 v[208:209], v236 offset:18432
    ds_read_b64_tr_b16 v[210:211], v236 offset:19968
    s_waitcnt lgkmcnt(12)
    v_mfma_f32_32x32x16_bf16 v[64:79], v[184:187], v[24:27], v[64:79]
    ds_read_b64_tr_b16 v[212:213], v237 offset:18432
    ds_read_b64_tr_b16 v[214:215], v237 offset:19968
    s_waitcnt lgkmcnt(12)
    v_mfma_f32_32x32x16_bf16 v[80:95], v[188:191], v[24:27], v[80:95]
    ds_read_b64_tr_b16 v[216:217], v236 offset:18560
    ds_read_b64_tr_b16 v[218:219], v236 offset:20096
    s_waitcnt lgkmcnt(12)
    v_mfma_f32_32x32x16_bf16 v[96:111], v[192:195], v[24:27], v[96:111]
    ds_read_b64_tr_b16 v[220:221], v237 offset:18560
    ds_read_b64_tr_b16 v[222:223], v237 offset:20096
    s_waitcnt lgkmcnt(12)
    v_mfma_f32_32x32x16_bf16 v[112:127], v[196:199], v[24:27], v[112:127]
    ds_read_b64_tr_b16 v[224:225], v236 offset:18688
    ds_read_b64_tr_b16 v[226:227], v236 offset:20224
    s_waitcnt lgkmcnt(12)
    v_mfma_f32_32x32x16_bf16 v[128:143], v[200:203], v[24:27], v[128:143]
    ds_read_b64_tr_b16 v[228:229], v237 offset:18688
    ds_read_b64_tr_b16 v[230:231], v237 offset:20224
    s_waitcnt lgkmcnt(12)
    v_mfma_f32_32x32x16_bf16 v[144:159], v[204:207], v[24:27], v[144:159]
    s_waitcnt lgkmcnt(10)
    v_mfma_f32_32x32x16_bf16 v[64:79], v[208:211], v[28:31], v[64:79]
    s_waitcnt lgkmcnt(8)
    v_mfma_f32_32x32x16_bf16 v[80:95], v[212:215], v[28:31], v[80:95]
    s_waitcnt lgkmcnt(6)
    v_mfma_f32_32x32x16_bf16 v[96:111], v[216:219], v[28:31], v[96:111]
    s_waitcnt lgkmcnt(4)
    v_mfma_f32_32x32x16_bf16 v[112:127], v[220:223], v[28:31], v[112:127]
    s_waitcnt lgkmcnt(2)
    v_mfma_f32_32x32x16_bf16 v[128:143], v[224:227], v[28:31], v[128:143]
    s_waitcnt lgkmcnt(0)
    v_mfma_f32_32x32x16_bf16 v[144:159], v[228:231], v[28:31], v[144:159]
    s_barrier
    v_add_u32 v236, 24576, v10
    v_add_u32 v237, 24576, v11
    buffer_load_dwordx4 v[16:19], v250, s[8:11], s54 offen offset:0
    buffer_load_dwordx4 v[20:23], v250, s[8:11], s54 offen offset:32
    buffer_load_dwordx4 v[24:27], v250, s[8:11], s54 offen offset:64
    buffer_load_dwordx4 v[28:31], v250, s[8:11], s54 offen offset:96
    s_add_u32 s54, s54, 128
    s_cmp_eq_u32 s54, 1280
    s_cselect_b32 s54, 0, s54
    s_waitcnt vmcnt(12)
    ds_read_b64_tr_b16 v[184:185], v236 offset:0
    ds_read_b64_tr_b16 v[186:187], v236 offset:1536
    ds_read_b64_tr_b16 v[188:189], v237 offset:0
    ds_read_b64_tr_b16 v[190:191], v237 offset:1536
    ds_read_b64_tr_b16 v[192:193], v236 offset:128
    ds_read_b64_tr_b16 v[194:195], v236 offset:1664
    ds_read_b64_tr_b16 v[196:197], v237 offset:128
    ds_read_b64_tr_b16 v[198:199], v237 offset:1664
    ds_read_b64_tr_b16 v[200:201], v236 offset:256
    ds_read_b64_tr_b16 v[202:203], v236 offset:1792
    ds_read_b64_tr_b16 v[204:205], v237 offset:256
    ds_read_b64_tr_b16 v[206:207], v237 offset:1792
    ds_read_b64_tr_b16 v[208:209], v236 offset:6144
    ds_read_b64_tr_b16 v[210:211], v236 offset:7680
    s_waitcnt lgkmcnt(12)
    v_mfma_f32_32x32x16_bf16 v[64:79], v[184:187], v[32:35], v[64:79]
    ds_read_b64_tr_b16 v[212:213], v237 offset:6144
    ds_read_b64_tr_b16 v[214:215], v237 offset:7680
    s_waitcnt lgkmcnt(12)
    v_mfma_f32_32x32x16_bf16 v[80:95], v[188:191], v[32:35], v[80:95]
    ds_read_b64_tr_b16 v[216:217], v236 offset:6272
    ds_read_b64_tr_b16 v[218:219], v236 offset:7808
    s_waitcnt lgkmcnt(12)
    v_mfma_f32_32x32x16_bf16 v[96:111], v[192:195], v[32:35], v[96:111]
    ds_read_b64_tr_b16 v[220:221], v237 offset:6272
    ds_read_b64_tr_b16 v[222:223], v237 offset:7808
    s_waitcnt lgkmcnt(12)
    v_mfma_f32_32x32x16_bf16 v[112:127], v[196:199], v[32:35], v[112:127]
    ds_read_b64_tr_b16 v[224:225], v236 offset:6400
    ds_read_b64_tr_b16 v[226:227], v236 offset:7936
    s_waitcnt lgkmcnt(12)
    v_mfma_f32_32x32x16_bf16 v[128:143], v[200:203], v[32:35], v[128:143]
    ds_read_b64_tr_b16 v[228:229], v237 offset:6400
    ds_read_b64_tr_b16 v[230:231], v237 offset:7936
    s_waitcnt lgkmcnt(12)
    v_mfma_f32_32x32x16_bf16 v[144:159], v[204:207], v[32:35], v[144:159]
    ds_read_b64_tr_b16 v[184:185], v236 offset:12288
    ds_read_b64_tr_b16 v[186:187], v236 offset:13824
    s_waitcnt lgkmcnt(12)
    v_mfma_f32_32x32x16_bf16 v[64:79], v[208:211], v[36:39], v[64:79]
    ds_read_b64_tr_b16 v[188:189], v237 offset:12288
    ds_read_b64_tr_b16 v[190:191], v237 offset:13824
    s_waitcnt lgkmcnt(12)
    v_mfma_f32_32x32x16_bf16 v[80:95], v[212:215], v[36:39], v[80:95]
    ds_read_b64_tr_b16 v[192:193], v236 offset:12416
    ds_read_b64_tr_b16 v[194:195], v236 offset:13952
    s_waitcnt lgkmcnt(12)
    v_mfma_f32_32x32x16_bf16 v[96:111], v[216:219], v[36:39], v[96:111]
    ds_read_b64_tr_b16 v[196:197], v237 offset:12416
    ds_read_b64_tr_b16 v[198:199], v237 offset:13952
    s_waitcnt lgkmcnt(12)
    v_mfma_f32_32x32x16_bf16 v[112:127], v[220:223], v[36:39], v[112:127]
    ds_read_b64_tr_b16 v[200:201], v236 offset:12544
    ds_read_b64_tr_b16 v[202:203], v236 offset:14080
    s_waitcnt lgkmcnt(12)
    v_mfma_f32_32x32x16_bf16 v[128:143], v[224:227], v[36:39], v[128:143]
    ds_read_b64_tr_b16 v[204:205], v237 offset:12544
    ds_read_b64_tr_b16 v[206:207], v237 offset:14080
    s_waitcnt lgkmcnt(12)
    v_mfma_f32_32x32x16_bf16 v[144:159], v[228:231], v[36:39], v[144:159]
    ds_read_b64_tr_b16 v[208:209], v236 offset:18432
    ds_read_b64_tr_b16 v[210:211], v236 offset:19968
    s_waitcnt lgkmcnt(12)
    v_mfma_f32_32x32x16_bf16 v[64:79], v[184:187], v[40:43], v[64:79]
    ds_read_b64_tr_b16 v[212:213], v237 offset:18432
    ds_read_b64_tr_b16 v[214:215], v237 offset:19968
    s_waitcnt lgkmcnt(12)
    v_mfma_f32_32x32x16_bf16 v[80:95], v[188:191], v[40:43], v[80:95]
    ds_read_b64_tr_b16 v[216:217], v236 offset:18560
    ds_read_b64_tr_b16 v[218:219], v236 offset:20096
    s_waitcnt lgkmcnt(12)
    v_mfma_f32_32x32x16_bf16 v[96:111], v[192:195], v[40:43], v[96:111]
    ds_read_b64_tr_b16 v[220:221], v237 offset:18560
    ds_read_b64_tr_b16 v[222:223], v237 offset:20096
    s_waitcnt lgkmcnt(12)
    v_mfma_f32_32x32x16_bf16 v[112:127], v[196:199], v[40:43], v[112:127]
    ds_read_b64_tr_b16 v[224:225], v236 offset:18688
    ds_read_b64_tr_b16 v[226:227], v236 offset:20224
    s_waitcnt lgkmcnt(12)
    v_mfma_f32_32x32x16_bf16 v[128:143], v[200:203], v[40:43], v[128:143]
    ds_read_b64_tr_b16 v[228:229], v237 offset:18688
    ds_read_b64_tr_b16 v[230:231], v237 offset:20224
    s_waitcnt lgkmcnt(12)
    v_mfma_f32_32x32x16_bf16 v[144:159], v[204:207], v[40:43], v[144:159]
    s_waitcnt lgkmcnt(10)
    v_mfma_f32_32x32x16_bf16 v[64:79], v[208:211], v[44:47], v[64:79]
    s_waitcnt lgkmcnt(8)
    v_mfma_f32_32x32x16_bf16 v[80:95], v[212:215], v[44:47], v[80:95]
    s_waitcnt lgkmcnt(6)
    v_mfma_f32_32x32x16_bf16 v[96:111], v[216:219], v[44:47], v[96:111]
    s_waitcnt lgkmcnt(4)
    v_mfma_f32_32x32x16_bf16 v[112:127], v[220:223], v[44:47], v[112:127]
    s_waitcnt lgkmcnt(2)
    v_mfma_f32_32x32x16_bf16 v[128:143], v[224:227], v[44:47], v[128:143]
    s_waitcnt lgkmcnt(0)
    v_mfma_f32_32x32x16_bf16 v[144:159], v[228:231], v[44:47], v[144:159]
    s_barrier
    v_add_u32 v236, 49152, v10
    v_add_u32 v237, 49152, v11
    buffer_load_dwordx4 v[32:35], v250, s[8:11], s54 offen offset:0
    buffer_load_dwordx4 v[36:39], v250, s[8:11], s54 offen offset:32
    buffer_load_dwordx4 v[40:43], v250, s[8:11], s54 offen offset:64
    buffer_load_dwordx4 v[44:47], v250, s[8:11], s54 offen offset:96
    s_add_u32 s54, s54, 128
    s_cmp_eq_u32 s54, 1280
    s_cselect_b32 s54, 0, s54
    s_waitcnt vmcnt(12)
    ds_read_b64_tr_b16 v[184:185], v236 offset:0
    ds_read_b64_tr_b16 v[186:187], v236 offset:1536
    ds_read_b64_tr_b16 v[188:189], v237 offset:0
    ds_read_b64_tr_b16 v[190:191], v237 offset:1536
    ds_read_b64_tr_b16 v[192:193], v236 offset:128
    ds_read_b64_tr_b16 v[194:195], v236 offset:1664
    ds_read_b64_tr_b16 v[196:197], v237 offset:128
    ds_read_b64_tr_b16 v[198:199], v237 offset:1664
    ds_read_b64_tr_b16 v[200:201], v236 offset:256
    ds_read_b64_tr_b16 v[202:203], v236 offset:1792
    ds_read_b64_tr_b16 v[204:205], v237 offset:256
    ds_read_b64_tr_b16 v[206:207], v237 offset:1792
    ds_read_b64_tr_b16 v[208:209], v236 offset:6144
    ds_read_b64_tr_b16 v[210:211], v236 offset:7680
    s_waitcnt lgkmcnt(12)
    v_mfma_f32_32x32x16_bf16 v[64:79], v[184:187], v[48:51], v[64:79]
    ds_read_b64_tr_b16 v[212:213], v237 offset:6144
    ds_read_b64_tr_b16 v[214:215], v237 offset:7680
    s_waitcnt lgkmcnt(12)
    v_mfma_f32_32x32x16_bf16 v[80:95], v[188:191], v[48:51], v[80:95]
    ds_read_b64_tr_b16 v[216:217], v236 offset:6272
    ds_read_b64_tr_b16 v[218:219], v236 offset:7808
    s_waitcnt lgkmcnt(12)
    v_mfma_f32_32x32x16_bf16 v[96:111], v[192:195], v[48:51], v[96:111]
    ds_read_b64_tr_b16 v[220:221], v237 offset:6272
    ds_read_b64_tr_b16 v[222:223], v237 offset:7808
    s_waitcnt lgkmcnt(12)
    v_mfma_f32_32x32x16_bf16 v[112:127], v[196:199], v[48:51], v[112:127]
    ds_read_b64_tr_b16 v[224:225], v236 offset:6400
    ds_read_b64_tr_b16 v[226:227], v236 offset:7936
    s_waitcnt lgkmcnt(12)
    v_mfma_f32_32x32x16_bf16 v[128:143], v[200:203], v[48:51], v[128:143]
    ds_read_b64_tr_b16 v[228:229], v237 offset:6400
    ds_read_b64_tr_b16 v[230:231], v237 offset:7936
    s_waitcnt lgkmcnt(12)
    v_mfma_f32_32x32x16_bf16 v[144:159], v[204:207], v[48:51], v[144:159]
    ds_read_b64_tr_b16 v[184:185], v236 offset:12288
    ds_read_b64_tr_b16 v[186:187], v236 offset:13824
    s_waitcnt lgkmcnt(12)
    v_mfma_f32_32x32x16_bf16 v[64:79], v[208:211], v[52:55], v[64:79]
    ds_read_b64_tr_b16 v[188:189], v237 offset:12288
    ds_read_b64_tr_b16 v[190:191], v237 offset:13824
    s_waitcnt lgkmcnt(12)
    v_mfma_f32_32x32x16_bf16 v[80:95], v[212:215], v[52:55], v[80:95]
    ds_read_b64_tr_b16 v[192:193], v236 offset:12416
    ds_read_b64_tr_b16 v[194:195], v236 offset:13952
    s_waitcnt lgkmcnt(12)
    v_mfma_f32_32x32x16_bf16 v[96:111], v[216:219], v[52:55], v[96:111]
    ds_read_b64_tr_b16 v[196:197], v237 offset:12416
    ds_read_b64_tr_b16 v[198:199], v237 offset:13952
    s_waitcnt lgkmcnt(12)
    v_mfma_f32_32x32x16_bf16 v[112:127], v[220:223], v[52:55], v[112:127]
    ds_read_b64_tr_b16 v[200:201], v236 offset:12544
    ds_read_b64_tr_b16 v[202:203], v236 offset:14080
    s_waitcnt lgkmcnt(12)
    v_mfma_f32_32x32x16_bf16 v[128:143], v[224:227], v[52:55], v[128:143]
    ds_read_b64_tr_b16 v[204:205], v237 offset:12544
    ds_read_b64_tr_b16 v[206:207], v237 offset:14080
    s_waitcnt lgkmcnt(12)
    v_mfma_f32_32x32x16_bf16 v[144:159], v[228:231], v[52:55], v[144:159]
    ds_read_b64_tr_b16 v[208:209], v236 offset:18432
    ds_read_b64_tr_b16 v[210:211], v236 offset:19968
    s_waitcnt lgkmcnt(12)
    v_mfma_f32_32x32x16_bf16 v[64:79], v[184:187], v[56:59], v[64:79]
    ds_read_b64_tr_b16 v[212:213], v237 offset:18432
    ds_read_b64_tr_b16 v[214:215], v237 offset:19968
    s_waitcnt lgkmcnt(12)
    v_mfma_f32_32x32x16_bf16 v[80:95], v[188:191], v[56:59], v[80:95]
    ds_read_b64_tr_b16 v[216:217], v236 offset:18560
    ds_read_b64_tr_b16 v[218:219], v236 offset:20096
    s_waitcnt lgkmcnt(12)
    v_mfma_f32_32x32x16_bf16 v[96:111], v[192:195], v[56:59], v[96:111]
    ds_read_b64_tr_b16 v[220:221], v237 offset:18560
    ds_read_b64_tr_b16 v[222:223], v237 offset:20096
    s_waitcnt lgkmcnt(12)
    v_mfma_f32_32x32x16_bf16 v[112:127], v[196:199], v[56:59], v[112:127]
    ds_read_b64_tr_b16 v[224:225], v236 offset:18688
    ds_read_b64_tr_b16 v[226:227], v236 offset:20224
    s_waitcnt lgkmcnt(12)
    v_mfma_f32_32x32x16_bf16 v[128:143], v[200:203], v[56:59], v[128:143]
    ds_read_b64_tr_b16 v[228:229], v237 offset:18688
    ds_read_b64_tr_b16 v[230:231], v237 offset:20224
    s_waitcnt lgkmcnt(12)
    v_mfma_f32_32x32x16_bf16 v[144:159], v[204:207], v[56:59], v[144:159]
    s_waitcnt lgkmcnt(10)
    v_mfma_f32_32x32x16_bf16 v[64:79], v[208:211], v[60:63], v[64:79]
    s_waitcnt lgkmcnt(8)
    v_mfma_f32_32x32x16_bf16 v[80:95], v[212:215], v[60:63], v[80:95]
    s_waitcnt lgkmcnt(6)
    v_mfma_f32_32x32x16_bf16 v[96:111], v[216:219], v[60:63], v[96:111]
    s_waitcnt lgkmcnt(4)
    v_mfma_f32_32x32x16_bf16 v[112:127], v[220:223], v[60:63], v[112:127]
    s_waitcnt lgkmcnt(2)
    v_mfma_f32_32x32x16_bf16 v[128:143], v[224:227], v[60:63], v[128:143]
    s_waitcnt lgkmcnt(0)
    v_mfma_f32_32x32x16_bf16 v[144:159], v[228:231], v[60:63], v[144:159]
    s_barrier
    v_add_u32 v236, 73728, v10
    v_add_u32 v237, 73728, v11
    buffer_load_dwordx4 v[48:51], v250, s[8:11], s54 offen offset:0
    buffer_load_dwordx4 v[52:55], v250, s[8:11], s54 offen offset:32
    buffer_load_dwordx4 v[56:59], v250, s[8:11], s54 offen offset:64
    buffer_load_dwordx4 v[60:63], v250, s[8:11], s54 offen offset:96
    s_add_u32 s54, s54, 128
    s_cmp_eq_u32 s54, 1280
    s_cselect_b32 s54, 0, s54
    s_waitcnt vmcnt(12)
    ds_read_b64_tr_b16 v[184:185], v236 offset:0
    ds_read_b64_tr_b16 v[186:187], v236 offset:1536
    ds_read_b64_tr_b16 v[188:189], v237 offset:0
    ds_read_b64_tr_b16 v[190:191], v237 offset:1536
    ds_read_b64_tr_b16 v[192:193], v236 offset:128
    ds_read_b64_tr_b16 v[194:195], v236 offset:1664
    ds_read_b64_tr_b16 v[196:197], v237 offset:128
    ds_read_b64_tr_b16 v[198:199], v237 offset:1664
    ds_read_b64_tr_b16 v[200:201], v236 offset:256
    ds_read_b64_tr_b16 v[202:203], v236 offset:1792
    ds_read_b64_tr_b16 v[204:205], v237 offset:256
    ds_read_b64_tr_b16 v[206:207], v237 offset:1792
    ds_read_b64_tr_b16 v[208:209], v236 offset:6144
    ds_read_b64_tr_b16 v[210:211], v236 offset:7680
    s_waitcnt lgkmcnt(12)
    v_mfma_f32_32x32x16_bf16 v[64:79], v[184:187], v[160:163], v[64:79]
    ds_read_b64_tr_b16 v[212:213], v237 offset:6144
    ds_read_b64_tr_b16 v[214:215], v237 offset:7680
    s_waitcnt lgkmcnt(12)
    v_mfma_f32_32x32x16_bf16 v[80:95], v[188:191], v[160:163], v[80:95]
    ds_read_b64_tr_b16 v[216:217], v236 offset:6272
    ds_read_b64_tr_b16 v[218:219], v236 offset:7808
    s_waitcnt lgkmcnt(12)
    v_mfma_f32_32x32x16_bf16 v[96:111], v[192:195], v[160:163], v[96:111]
    ds_read_b64_tr_b16 v[220:221], v237 offset:6272
    ds_read_b64_tr_b16 v[222:223], v237 offset:7808
    s_waitcnt lgkmcnt(12)
    v_mfma_f32_32x32x16_bf16 v[112:127], v[196:199], v[160:163], v[112:127]
    ds_read_b64_tr_b16 v[224:225], v236 offset:6400
    ds_read_b64_tr_b16 v[226:227], v236 offset:7936
    s_waitcnt lgkmcnt(12)
    v_mfma_f32_32x32x16_bf16 v[128:143], v[200:203], v[160:163], v[128:143]
    ds_read_b64_tr_b16 v[228:229], v237 offset:6400
    ds_read_b64_tr_b16 v[230:231], v237 offset:7936
    s_waitcnt lgkmcnt(12)
    v_mfma_f32_32x32x16_bf16 v[144:159], v[204:207], v[160:163], v[144:159]
    ds_read_b64_tr_b16 v[184:185], v236 offset:12288
    ds_read_b64_tr_b16 v[186:187], v236 offset:13824
    s_waitcnt lgkmcnt(12)
    v_mfma_f32_32x32x16_bf16 v[64:79], v[208:211], v[164:167], v[64:79]
    ds_read_b64_tr_b16 v[188:189], v237 offset:12288
    ds_read_b64_tr_b16 v[190:191], v237 offset:13824
    s_waitcnt lgkmcnt(12)
    v_mfma_f32_32x32x16_bf16 v[80:95], v[212:215], v[164:167], v[80:95]
    ds_read_b64_tr_b16 v[192:193], v236 offset:12416
    ds_read_b64_tr_b16 v[194:195], v236 offset:13952
    s_waitcnt lgkmcnt(12)
    v_mfma_f32_32x32x16_bf16 v[96:111], v[216:219], v[164:167], v[96:111]
    ds_read_b64_tr_b16 v[196:197], v237 offset:12416
    ds_read_b64_tr_b16 v[198:199], v237 offset:13952
    s_waitcnt lgkmcnt(12)
    v_mfma_f32_32x32x16_bf16 v[112:127], v[220:223], v[164:167], v[112:127]
    ds_read_b64_tr_b16 v[200:201], v236 offset:12544
    ds_read_b64_tr_b16 v[202:203], v236 offset:14080
    s_waitcnt lgkmcnt(12)
    v_mfma_f32_32x32x16_bf16 v[128:143], v[224:227], v[164:167], v[128:143]
    ds_read_b64_tr_b16 v[204:205], v237 offset:12544
    ds_read_b64_tr_b16 v[206:207], v237 offset:14080
    s_waitcnt lgkmcnt(12)
    v_mfma_f32_32x32x16_bf16 v[144:159], v[228:231], v[164:167], v[144:159]
    ds_read_b64_tr_b16 v[208:209], v236 offset:18432
    ds_read_b64_tr_b16 v[210:211], v236 offset:19968
    s_waitcnt lgkmcnt(12)
    v_mfma_f32_32x32x16_bf16 v[64:79], v[184:187], v[168:171], v[64:79]
    ds_read_b64_tr_b16 v[212:213], v237 offset:18432
    ds_read_b64_tr_b16 v[214:215], v237 offset:19968
    s_waitcnt lgkmcnt(12)
    v_mfma_f32_32x32x16_bf16 v[80:95], v[188:191], v[168:171], v[80:95]
    ds_read_b64_tr_b16 v[216:217], v236 offset:18560
    ds_read_b64_tr_b16 v[218:219], v236 offset:20096
    s_waitcnt lgkmcnt(12)
    v_mfma_f32_32x32x16_bf16 v[96:111], v[192:195], v[168:171], v[96:111]
    ds_read_b64_tr_b16 v[220:221], v237 offset:18560
    ds_read_b64_tr_b16 v[222:223], v237 offset:20096
    s_waitcnt lgkmcnt(12)
    v_mfma_f32_32x32x16_bf16 v[112:127], v[196:199], v[168:171], v[112:127]
    ds_read_b64_tr_b16 v[224:225], v236 offset:18688
    ds_read_b64_tr_b16 v[226:227], v236 offset:20224
    s_waitcnt lgkmcnt(12)
    v_mfma_f32_32x32x16_bf16 v[128:143], v[200:203], v[168:171], v[128:143]
    ds_read_b64_tr_b16 v[228:229], v237 offset:18688
    ds_read_b64_tr_b16 v[230:231], v237 offset:20224
    s_waitcnt lgkmcnt(12)
    v_mfma_f32_32x32x16_bf16 v[144:159], v[204:207], v[168:171], v[144:159]
    s_waitcnt lgkmcnt(10)
    v_mfma_f32_32x32x16_bf16 v[64:79], v[208:211], v[172:175], v[64:79]
    s_waitcnt lgkmcnt(8)
    v_mfma_f32_32x32x16_bf16 v[80:95], v[212:215], v[172:175], v[80:95]
    s_waitcnt lgkmcnt(6)
    v_mfma_f32_32x32x16_bf16 v[96:111], v[216:219], v[172:175], v[96:111]
    s_waitcnt lgkmcnt(4)
    v_mfma_f32_32x32x16_bf16 v[112:127], v[220:223], v[172:175], v[112:127]
    s_waitcnt lgkmcnt(2)
    v_mfma_f32_32x32x16_bf16 v[128:143], v[224:227], v[172:175], v[128:143]
    s_waitcnt lgkmcnt(0)
    v_mfma_f32_32x32x16_bf16 v[144:159], v[228:231], v[172:175], v[144:159]
    s_barrier
    v_add_u32 v236, 0, v10
    v_add_u32 v237, 0, v11
    buffer_load_dwordx4 v[160:163], v250, s[8:11], s54 offen offset:0
    buffer_load_dwordx4 v[164:167], v250, s[8:11], s54 offen offset:32
    buffer_load_dwordx4 v[168:171], v250, s[8:11], s54 offen offset:64
    buffer_load_dwordx4 v[172:175], v250, s[8:11], s54 offen offset:96
    s_add_u32 s54, s54, 128
    s_cmp_eq_u32 s54, 1280
    s_cselect_b32 s54, 0, s54
    s_waitcnt vmcnt(12)
    ds_read_b64_tr_b16 v[184:185], v236 offset:0
    ds_read_b64_tr_b16 v[186:187], v236 offset:1536
    ds_read_b64_tr_b16 v[188:189], v237 offset:0
    ds_read_b64_tr_b16 v[190:191], v237 offset:1536
    ds_read_b64_tr_b16 v[192:193], v236 offset:128
    ds_read_b64_tr_b16 v[194:195], v236 offset:1664
    ds_read_b64_tr_b16 v[196:197], v237 offset:128
    ds_read_b64_tr_b16 v[198:199], v237 offset:1664
    ds_read_b64_tr_b16 v[200:201], v236 offset:256
    ds_read_b64_tr_b16 v[202:203], v236 offset:1792
    ds_read_b64_tr_b16 v[204:205], v237 offset:256
    ds_read_b64_tr_b16 v[206:207], v237 offset:1792
    ds_read_b64_tr_b16 v[208:209], v236 offset:6144
    ds_read_b64_tr_b16 v[210:211], v236 offset:7680
    s_waitcnt lgkmcnt(12)
    v_mfma_f32_32x32x16_bf16 v[64:79], v[184:187], v[16:19], v[64:79]
    ds_read_b64_tr_b16 v[212:213], v237 offset:6144
    ds_read_b64_tr_b16 v[214:215], v237 offset:7680
    s_waitcnt lgkmcnt(12)
    v_mfma_f32_32x32x16_bf16 v[80:95], v[188:191], v[16:19], v[80:95]
    ds_read_b64_tr_b16 v[216:217], v236 offset:6272
    ds_read_b64_tr_b16 v[218:219], v236 offset:7808
    s_waitcnt lgkmcnt(12)
    v_mfma_f32_32x32x16_bf16 v[96:111], v[192:195], v[16:19], v[96:111]
    ds_read_b64_tr_b16 v[220:221], v237 offset:6272
    ds_read_b64_tr_b16 v[222:223], v237 offset:7808
    s_waitcnt lgkmcnt(12)
    v_mfma_f32_32x32x16_bf16 v[112:127], v[196:199], v[16:19], v[112:127]
    ds_read_b64_tr_b16 v[224:225], v236 offset:6400
    ds_read_b64_tr_b16 v[226:227], v236 offset:7936
    s_waitcnt lgkmcnt(12)
    v_mfma_f32_32x32x16_bf16 v[128:143], v[200:203], v[16:19], v[128:143]
    ds_read_b64_tr_b16 v[228:229], v237 offset:6400
    ds_read_b64_tr_b16 v[230:231], v237 offset:7936
    s_waitcnt lgkmcnt(12)
    v_mfma_f32_32x32x16_bf16 v[144:159], v[204:207], v[16:19], v[144:159]
    ds_read_b64_tr_b16 v[184:185], v236 offset:12288
    ds_read_b64_tr_b16 v[186:187], v236 offset:13824
    s_waitcnt lgkmcnt(12)
    v_mfma_f32_32x32x16_bf16 v[64:79], v[208:211], v[20:23], v[64:79]
    ds_read_b64_tr_b16 v[188:189], v237 offset:12288
    ds_read_b64_tr_b16 v[190:191], v237 offset:13824
    s_waitcnt lgkmcnt(12)
    v_mfma_f32_32x32x16_bf16 v[80:95], v[212:215], v[20:23], v[80:95]
    ds_read_b64_tr_b16 v[192:193], v236 offset:12416
    ds_read_b64_tr_b16 v[194:195], v236 offset:13952
    s_waitcnt lgkmcnt(12)
    v_mfma_f32_32x32x16_bf16 v[96:111], v[216:219], v[20:23], v[96:111]
    ds_read_b64_tr_b16 v[196:197], v237 offset:12416
    ds_read_b64_tr_b16 v[198:199], v237 offset:13952
    s_waitcnt lgkmcnt(12)
    v_mfma_f32_32x32x16_bf16 v[112:127], v[220:223], v[20:23], v[112:127]
    ds_read_b64_tr_b16 v[200:201], v236 offset:12544
    ds_read_b64_tr_b16 v[202:203], v236 offset:14080
    s_waitcnt lgkmcnt(12)
    v_mfma_f32_32x32x16_bf16 v[128:143], v[224:227], v[20:23], v[128:143]
    ds_read_b64_tr_b16 v[204:205], v237 offset:12544
    ds_read_b64_tr_b16 v[206:207], v237 offset:14080
    s_waitcnt lgkmcnt(12)
    v_mfma_f32_32x32x16_bf16 v[144:159], v[228:231], v[20:23], v[144:159]
    ds_read_b64_tr_b16 v[208:209], v236 offset:18432
    ds_read_b64_tr_b16 v[210:211], v236 offset:19968
    s_waitcnt lgkmcnt(12)
    v_mfma_f32_32x32x16_bf16 v[64:79], v[184:187], v[24:27], v[64:79]
    ds_read_b64_tr_b16 v[212:213], v237 offset:18432
    ds_read_b64_tr_b16 v[214:215], v237 offset:19968
    s_waitcnt lgkmcnt(12)
    v_mfma_f32_32x32x16_bf16 v[80:95], v[188:191], v[24:27], v[80:95]
    ds_read_b64_tr_b16 v[216:217], v236 offset:18560
    ds_read_b64_tr_b16 v[218:219], v236 offset:20096
    s_waitcnt lgkmcnt(12)
    v_mfma_f32_32x32x16_bf16 v[96:111], v[192:195], v[24:27], v[96:111]
    ds_read_b64_tr_b16 v[220:221], v237 offset:18560
    ds_read_b64_tr_b16 v[222:223], v237 offset:20096
    s_waitcnt lgkmcnt(12)
    v_mfma_f32_32x32x16_bf16 v[112:127], v[196:199], v[24:27], v[112:127]
    ds_read_b64_tr_b16 v[224:225], v236 offset:18688
    ds_read_b64_tr_b16 v[226:227], v236 offset:20224
    s_waitcnt lgkmcnt(12)
    v_mfma_f32_32x32x16_bf16 v[128:143], v[200:203], v[24:27], v[128:143]
    ds_read_b64_tr_b16 v[228:229], v237 offset:18688
    ds_read_b64_tr_b16 v[230:231], v237 offset:20224
    s_waitcnt lgkmcnt(12)
    v_mfma_f32_32x32x16_bf16 v[144:159], v[204:207], v[24:27], v[144:159]
    s_waitcnt lgkmcnt(10)
    v_mfma_f32_32x32x16_bf16 v[64:79], v[208:211], v[28:31], v[64:79]
    s_waitcnt lgkmcnt(8)
    v_mfma_f32_32x32x16_bf16 v[80:95], v[212:215], v[28:31], v[80:95]
    s_waitcnt lgkmcnt(6)
    v_mfma_f32_32x32x16_bf16 v[96:111], v[216:219], v[28:31], v[96:111]
    s_waitcnt lgkmcnt(4)
    v_mfma_f32_32x32x16_bf16 v[112:127], v[220:223], v[28:31], v[112:127]
    s_waitcnt lgkmcnt(2)
    v_mfma_f32_32x32x16_bf16 v[128:143], v[224:227], v[28:31], v[128:143]
    s_waitcnt lgkmcnt(0)
    v_mfma_f32_32x32x16_bf16 v[144:159], v[228:231], v[28:31], v[144:159]
    s_barrier
    v_add_u32 v236, 24576, v10
    v_add_u32 v237, 24576, v11
    buffer_load_dwordx4 v[16:19], v250, s[8:11], s54 offen offset:0
    buffer_load_dwordx4 v[20:23], v250, s[8:11], s54 offen offset:32
    buffer_load_dwordx4 v[24:27], v250, s[8:11], s54 offen offset:64
    buffer_load_dwordx4 v[28:31], v250, s[8:11], s54 offen offset:96
    s_add_u32 s54, s54, 128
    s_cmp_eq_u32 s54, 1280
    s_cselect_b32 s54, 0, s54
    s_waitcnt vmcnt(12)
    ds_read_b64_tr_b16 v[184:185], v236 offset:0
    ds_read_b64_tr_b16 v[186:187], v236 offset:1536
    ds_read_b64_tr_b16 v[188:189], v237 offset:0
    ds_read_b64_tr_b16 v[190:191], v237 offset:1536
    ds_read_b64_tr_b16 v[192:193], v236 offset:128
    ds_read_b64_tr_b16 v[194:195], v236 offset:1664
    ds_read_b64_tr_b16 v[196:197], v237 offset:128
    ds_read_b64_tr_b16 v[198:199], v237 offset:1664
    ds_read_b64_tr_b16 v[200:201], v236 offset:256
    ds_read_b64_tr_b16 v[202:203], v236 offset:1792
    ds_read_b64_tr_b16 v[204:205], v237 offset:256
    ds_read_b64_tr_b16 v[206:207], v237 offset:1792
    ds_read_b64_tr_b16 v[208:209], v236 offset:6144
    ds_read_b64_tr_b16 v[210:211], v236 offset:7680
    s_waitcnt lgkmcnt(12)
    v_mfma_f32_32x32x16_bf16 v[64:79], v[184:187], v[32:35], v[64:79]
    ds_read_b64_tr_b16 v[212:213], v237 offset:6144
    ds_read_b64_tr_b16 v[214:215], v237 offset:7680
    s_waitcnt lgkmcnt(12)
    v_mfma_f32_32x32x16_bf16 v[80:95], v[188:191], v[32:35], v[80:95]
    ds_read_b64_tr_b16 v[216:217], v236 offset:6272
    ds_read_b64_tr_b16 v[218:219], v236 offset:7808
    s_waitcnt lgkmcnt(12)
    v_mfma_f32_32x32x16_bf16 v[96:111], v[192:195], v[32:35], v[96:111]
    ds_read_b64_tr_b16 v[220:221], v237 offset:6272
    ds_read_b64_tr_b16 v[222:223], v237 offset:7808
    s_waitcnt lgkmcnt(12)
    v_mfma_f32_32x32x16_bf16 v[112:127], v[196:199], v[32:35], v[112:127]
    ds_read_b64_tr_b16 v[224:225], v236 offset:6400
    ds_read_b64_tr_b16 v[226:227], v236 offset:7936
    s_waitcnt lgkmcnt(12)
    v_mfma_f32_32x32x16_bf16 v[128:143], v[200:203], v[32:35], v[128:143]
    ds_read_b64_tr_b16 v[228:229], v237 offset:6400
    ds_read_b64_tr_b16 v[230:231], v237 offset:7936
    s_waitcnt lgkmcnt(12)
    v_mfma_f32_32x32x16_bf16 v[144:159], v[204:207], v[32:35], v[144:159]
    ds_read_b64_tr_b16 v[184:185], v236 offset:12288
    ds_read_b64_tr_b16 v[186:187], v236 offset:13824
    s_waitcnt lgkmcnt(12)
    v_mfma_f32_32x32x16_bf16 v[64:79], v[208:211], v[36:39], v[64:79]
    ds_read_b64_tr_b16 v[188:189], v237 offset:12288
    ds_read_b64_tr_b16 v[190:191], v237 offset:13824
    s_waitcnt lgkmcnt(12)
    v_mfma_f32_32x32x16_bf16 v[80:95], v[212:215], v[36:39], v[80:95]
    ds_read_b64_tr_b16 v[192:193], v236 offset:12416
    ds_read_b64_tr_b16 v[194:195], v236 offset:13952
    s_waitcnt lgkmcnt(12)
    v_mfma_f32_32x32x16_bf16 v[96:111], v[216:219], v[36:39], v[96:111]
    ds_read_b64_tr_b16 v[196:197], v237 offset:12416
    ds_read_b64_tr_b16 v[198:199], v237 offset:13952
    s_waitcnt lgkmcnt(12)
    v_mfma_f32_32x32x16_bf16 v[112:127], v[220:223], v[36:39], v[112:127]
    ds_read_b64_tr_b16 v[200:201], v236 offset:12544
    ds_read_b64_tr_b16 v[202:203], v236 offset:14080
    s_waitcnt lgkmcnt(12)
    v_mfma_f32_32x32x16_bf16 v[128:143], v[224:227], v[36:39], v[128:143]
    ds_read_b64_tr_b16 v[204:205], v237 offset:12544
    ds_read_b64_tr_b16 v[206:207], v237 offset:14080
    s_waitcnt lgkmcnt(12)
    v_mfma_f32_32x32x16_bf16 v[144:159], v[228:231], v[36:39], v[144:159]
    ds_read_b64_tr_b16 v[208:209], v236 offset:18432
    ds_read_b64_tr_b16 v[210:211], v236 offset:19968
    s_waitcnt lgkmcnt(12)
    v_mfma_f32_32x32x16_bf16 v[64:79], v[184:187], v[40:43], v[64:79]
    ds_read_b64_tr_b16 v[212:213], v237 offset:18432
    ds_read_b64_tr_b16 v[214:215], v237 offset:19968
    s_waitcnt lgkmcnt(12)
    v_mfma_f32_32x32x16_bf16 v[80:95], v[188:191], v[40:43], v[80:95]
    ds_read_b64_tr_b16 v[216:217], v236 offset:18560
    ds_read_b64_tr_b16 v[218:219], v236 offset:20096
    s_waitcnt lgkmcnt(12)
    v_mfma_f32_32x32x16_bf16 v[96:111], v[192:195], v[40:43], v[96:111]
    ds_read_b64_tr_b16 v[220:221], v237 offset:18560
    ds_read_b64_tr_b16 v[222:223], v237 offset:20096
    s_waitcnt lgkmcnt(12)
    v_mfma_f32_32x32x16_bf16 v[112:127], v[196:199], v[40:43], v[112:127]
    ds_read_b64_tr_b16 v[224:225], v236 offset:18688
    ds_read_b64_tr_b16 v[226:227], v236 offset:20224
    s_waitcnt lgkmcnt(12)
    v_mfma_f32_32x32x16_bf16 v[128:143], v[200:203], v[40:43], v[128:143]
    ds_read_b64_tr_b16 v[228:229], v237 offset:18688
    ds_read_b64_tr_b16 v[230:231], v237 offset:20224
    s_waitcnt lgkmcnt(12)
    v_mfma_f32_32x32x16_bf16 v[144:159], v[204:207], v[40:43], v[144:159]
    s_waitcnt lgkmcnt(10)
    v_mfma_f32_32x32x16_bf16 v[64:79], v[208:211], v[44:47], v[64:79]
    s_waitcnt lgkmcnt(8)
    v_mfma_f32_32x32x16_bf16 v[80:95], v[212:215], v[44:47], v[80:95]
    s_waitcnt lgkmcnt(6)
    v_mfma_f32_32x32x16_bf16 v[96:111], v[216:219], v[44:47], v[96:111]
    s_waitcnt lgkmcnt(4)
    v_mfma_f32_32x32x16_bf16 v[112:127], v[220:223], v[44:47], v[112:127]
    s_waitcnt lgkmcnt(2)
    v_mfma_f32_32x32x16_bf16 v[128:143], v[224:227], v[44:47], v[128:143]
    s_waitcnt lgkmcnt(0)
    v_mfma_f32_32x32x16_bf16 v[144:159], v[228:231], v[44:47], v[144:159]
    s_barrier
    v_add_u32 v236, 49152, v10
    v_add_u32 v237, 49152, v11
    buffer_load_dwordx4 v[32:35], v250, s[8:11], s54 offen offset:0
    buffer_load_dwordx4 v[36:39], v250, s[8:11], s54 offen offset:32
    buffer_load_dwordx4 v[40:43], v250, s[8:11], s54 offen offset:64
    buffer_load_dwordx4 v[44:47], v250, s[8:11], s54 offen offset:96
    s_add_u32 s54, s54, 128
    s_cmp_eq_u32 s54, 1280
    s_cselect_b32 s54, 0, s54
    s_waitcnt vmcnt(12)
    ds_read_b64_tr_b16 v[184:185], v236 offset:0
    ds_read_b64_tr_b16 v[186:187], v236 offset:1536
    ds_read_b64_tr_b16 v[188:189], v237 offset:0
    ds_read_b64_tr_b16 v[190:191], v237 offset:1536
    ds_read_b64_tr_b16 v[192:193], v236 offset:128
    ds_read_b64_tr_b16 v[194:195], v236 offset:1664
    ds_read_b64_tr_b16 v[196:197], v237 offset:128
    ds_read_b64_tr_b16 v[198:199], v237 offset:1664
    ds_read_b64_tr_b16 v[200:201], v236 offset:256
    ds_read_b64_tr_b16 v[202:203], v236 offset:1792
    ds_read_b64_tr_b16 v[204:205], v237 offset:256
    ds_read_b64_tr_b16 v[206:207], v237 offset:1792
    ds_read_b64_tr_b16 v[208:209], v236 offset:6144
    ds_read_b64_tr_b16 v[210:211], v236 offset:7680
    s_waitcnt lgkmcnt(12)
    v_mfma_f32_32x32x16_bf16 v[64:79], v[184:187], v[48:51], v[64:79]
    ds_read_b64_tr_b16 v[212:213], v237 offset:6144
    ds_read_b64_tr_b16 v[214:215], v237 offset:7680
    s_waitcnt lgkmcnt(12)
    v_mfma_f32_32x32x16_bf16 v[80:95], v[188:191], v[48:51], v[80:95]
    ds_read_b64_tr_b16 v[216:217], v236 offset:6272
    ds_read_b64_tr_b16 v[218:219], v236 offset:7808
    s_waitcnt lgkmcnt(12)
    v_mfma_f32_32x32x16_bf16 v[96:111], v[192:195], v[48:51], v[96:111]
    ds_read_b64_tr_b16 v[220:221], v237 offset:6272
    ds_read_b64_tr_b16 v[222:223], v237 offset:7808
    s_waitcnt lgkmcnt(12)
    v_mfma_f32_32x32x16_bf16 v[112:127], v[196:199], v[48:51], v[112:127]
    ds_read_b64_tr_b16 v[224:225], v236 offset:6400
    ds_read_b64_tr_b16 v[226:227], v236 offset:7936
    s_waitcnt lgkmcnt(12)
    v_mfma_f32_32x32x16_bf16 v[128:143], v[200:203], v[48:51], v[128:143]
    ds_read_b64_tr_b16 v[228:229], v237 offset:6400
    ds_read_b64_tr_b16 v[230:231], v237 offset:7936
    s_waitcnt lgkmcnt(12)
    v_mfma_f32_32x32x16_bf16 v[144:159], v[204:207], v[48:51], v[144:159]
    ds_read_b64_tr_b16 v[184:185], v236 offset:12288
    ds_read_b64_tr_b16 v[186:187], v236 offset:13824
    s_waitcnt lgkmcnt(12)
    v_mfma_f32_32x32x16_bf16 v[64:79], v[208:211], v[52:55], v[64:79]
    ds_read_b64_tr_b16 v[188:189], v237 offset:12288
    ds_read_b64_tr_b16 v[190:191], v237 offset:13824
    s_waitcnt lgkmcnt(12)
    v_mfma_f32_32x32x16_bf16 v[80:95], v[212:215], v[52:55], v[80:95]
    ds_read_b64_tr_b16 v[192:193], v236 offset:12416
    ds_read_b64_tr_b16 v[194:195], v236 offset:13952
    s_waitcnt lgkmcnt(12)
    v_mfma_f32_32x32x16_bf16 v[96:111], v[216:219], v[52:55], v[96:111]
    ds_read_b64_tr_b16 v[196:197], v237 offset:12416
    ds_read_b64_tr_b16 v[198:199], v237 offset:13952
    s_waitcnt lgkmcnt(12)
    v_mfma_f32_32x32x16_bf16 v[112:127], v[220:223], v[52:55], v[112:127]
    ds_read_b64_tr_b16 v[200:201], v236 offset:12544
    ds_read_b64_tr_b16 v[202:203], v236 offset:14080
    s_waitcnt lgkmcnt(12)
    v_mfma_f32_32x32x16_bf16 v[128:143], v[224:227], v[52:55], v[128:143]
    ds_read_b64_tr_b16 v[204:205], v237 offset:12544
    ds_read_b64_tr_b16 v[206:207], v237 offset:14080
    s_waitcnt lgkmcnt(12)
    v_mfma_f32_32x32x16_bf16 v[144:159], v[228:231], v[52:55], v[144:159]
    ds_read_b64_tr_b16 v[208:209], v236 offset:18432
    ds_read_b64_tr_b16 v[210:211], v236 offset:19968
    s_waitcnt lgkmcnt(12)
    v_mfma_f32_32x32x16_bf16 v[64:79], v[184:187], v[56:59], v[64:79]
    ds_read_b64_tr_b16 v[212:213], v237 offset:18432
    ds_read_b64_tr_b16 v[214:215], v237 offset:19968
    s_waitcnt lgkmcnt(12)
    v_mfma_f32_32x32x16_bf16 v[80:95], v[188:191], v[56:59], v[80:95]
    ds_read_b64_tr_b16 v[216:217], v236 offset:18560
    ds_read_b64_tr_b16 v[218:219], v236 offset:20096
    s_waitcnt lgkmcnt(12)
    v_mfma_f32_32x32x16_bf16 v[96:111], v[192:195], v[56:59], v[96:111]
    ds_read_b64_tr_b16 v[220:221], v237 offset:18560
    ds_read_b64_tr_b16 v[222:223], v237 offset:20096
    s_waitcnt lgkmcnt(12)
    v_mfma_f32_32x32x16_bf16 v[112:127], v[196:199], v[56:59], v[112:127]
    ds_read_b64_tr_b16 v[224:225], v236 offset:18688
    ds_read_b64_tr_b16 v[226:227], v236 offset:20224
    s_waitcnt lgkmcnt(12)
    v_mfma_f32_32x32x16_bf16 v[128:143], v[200:203], v[56:59], v[128:143]
    ds_read_b64_tr_b16 v[228:229], v237 offset:18688
    ds_read_b64_tr_b16 v[230:231], v237 offset:20224
    s_waitcnt lgkmcnt(12)
    v_mfma_f32_32x32x16_bf16 v[144:159], v[204:207], v[56:59], v[144:159]
    s_waitcnt lgkmcnt(10)
    v_mfma_f32_32x32x16_bf16 v[64:79], v[208:211], v[60:63], v[64:79]
    s_waitcnt lgkmcnt(8)
    v_mfma_f32_32x32x16_bf16 v[80:95], v[212:215], v[60:63], v[80:95]
    s_waitcnt lgkmcnt(6)
    v_mfma_f32_32x32x16_bf16 v[96:111], v[216:219], v[60:63], v[96:111]
    s_waitcnt lgkmcnt(4)
    v_mfma_f32_32x32x16_bf16 v[112:127], v[220:223], v[60:63], v[112:127]
    s_waitcnt lgkmcnt(2)
    v_mfma_f32_32x32x16_bf16 v[128:143], v[224:227], v[60:63], v[128:143]
    s_waitcnt lgkmcnt(0)
    v_mfma_f32_32x32x16_bf16 v[144:159], v[228:231], v[60:63], v[144:159]
    s_barrier
    v_add_u32 v236, 73728, v10
    v_add_u32 v237, 73728, v11
    s_waitcnt vmcnt(8)
    ds_read_b64_tr_b16 v[184:185], v236 offset:0
    ds_read_b64_tr_b16 v[186:187], v236 offset:1536
    ds_read_b64_tr_b16 v[188:189], v237 offset:0
    ds_read_b64_tr_b16 v[190:191], v237 offset:1536
    ds_read_b64_tr_b16 v[192:193], v236 offset:128
    ds_read_b64_tr_b16 v[194:195], v236 offset:1664
    ds_read_b64_tr_b16 v[196:197], v237 offset:128
    ds_read_b64_tr_b16 v[198:199], v237 offset:1664
    ds_read_b64_tr_b16 v[200:201], v236 offset:256
    ds_read_b64_tr_b16 v[202:203], v236 offset:1792
    ds_read_b64_tr_b16 v[204:205], v237 offset:256
    ds_read_b64_tr_b16 v[206:207], v237 offset:1792
    ds_read_b64_tr_b16 v[208:209], v236 offset:6144
    ds_read_b64_tr_b16 v[210:211], v236 offset:7680
    s_waitcnt lgkmcnt(12)
    v_mfma_f32_32x32x16_bf16 v[64:79], v[184:187], v[160:163], v[64:79]
    ds_read_b64_tr_b16 v[212:213], v237 offset:6144
    ds_read_b64_tr_b16 v[214:215], v237 offset:7680
    s_waitcnt lgkmcnt(12)
    v_mfma_f32_32x32x16_bf16 v[80:95], v[188:191], v[160:163], v[80:95]
    ds_read_b64_tr_b16 v[216:217], v236 offset:6272
    ds_read_b64_tr_b16 v[218:219], v236 offset:7808
    s_waitcnt lgkmcnt(12)
    v_mfma_f32_32x32x16_bf16 v[96:111], v[192:195], v[160:163], v[96:111]
    ds_read_b64_tr_b16 v[220:221], v237 offset:6272
    ds_read_b64_tr_b16 v[222:223], v237 offset:7808
    s_waitcnt lgkmcnt(12)
    v_mfma_f32_32x32x16_bf16 v[112:127], v[196:199], v[160:163], v[112:127]
    ds_read_b64_tr_b16 v[224:225], v236 offset:6400
    ds_read_b64_tr_b16 v[226:227], v236 offset:7936
    s_waitcnt lgkmcnt(12)
    v_mfma_f32_32x32x16_bf16 v[128:143], v[200:203], v[160:163], v[128:143]
    ds_read_b64_tr_b16 v[228:229], v237 offset:6400
    ds_read_b64_tr_b16 v[230:231], v237 offset:7936
    s_waitcnt lgkmcnt(12)
    v_mfma_f32_32x32x16_bf16 v[144:159], v[204:207], v[160:163], v[144:159]
    ds_read_b64_tr_b16 v[184:185], v236 offset:12288
    ds_read_b64_tr_b16 v[186:187], v236 offset:13824
    s_waitcnt lgkmcnt(12)
    v_mfma_f32_32x32x16_bf16 v[64:79], v[208:211], v[164:167], v[64:79]
    ds_read_b64_tr_b16 v[188:189], v237 offset:12288
    ds_read_b64_tr_b16 v[190:191], v237 offset:13824
    s_waitcnt lgkmcnt(12)
    v_mfma_f32_32x32x16_bf16 v[80:95], v[212:215], v[164:167], v[80:95]
    ds_read_b64_tr_b16 v[192:193], v236 offset:12416
    ds_read_b64_tr_b16 v[194:195], v236 offset:13952
    s_waitcnt lgkmcnt(12)
    v_mfma_f32_32x32x16_bf16 v[96:111], v[216:219], v[164:167], v[96:111]
    ds_read_b64_tr_b16 v[196:197], v237 offset:12416
    ds_read_b64_tr_b16 v[198:199], v237 offset:13952
    s_waitcnt lgkmcnt(12)
    v_mfma_f32_32x32x16_bf16 v[112:127], v[220:223], v[164:167], v[112:127]
    ds_read_b64_tr_b16 v[200:201], v236 offset:12544
    ds_read_b64_tr_b16 v[202:203], v236 offset:14080
    s_waitcnt lgkmcnt(12)
    v_mfma_f32_32x32x16_bf16 v[128:143], v[224:227], v[164:167], v[128:143]
    ds_read_b64_tr_b16 v[204:205], v237 offset:12544
    ds_read_b64_tr_b16 v[206:207], v237 offset:14080
    s_waitcnt lgkmcnt(12)
    v_mfma_f32_32x32x16_bf16 v[144:159], v[228:231], v[164:167], v[144:159]
    ds_read_b64_tr_b16 v[208:209], v236 offset:18432
    ds_read_b64_tr_b16 v[210:211], v236 offset:19968
    s_waitcnt lgkmcnt(12)
    v_mfma_f32_32x32x16_bf16 v[64:79], v[184:187], v[168:171], v[64:79]
    ds_read_b64_tr_b16 v[212:213], v237 offset:18432
    ds_read_b64_tr_b16 v[214:215], v237 offset:19968
    s_waitcnt lgkmcnt(12)
    v_mfma_f32_32x32x16_bf16 v[80:95], v[188:191], v[168:171], v[80:95]
    ds_read_b64_tr_b16 v[216:217], v236 offset:18560
    ds_read_b64_tr_b16 v[218:219], v236 offset:20096
    s_waitcnt lgkmcnt(12)
    v_mfma_f32_32x32x16_bf16 v[96:111], v[192:195], v[168:171], v[96:111]
    ds_read_b64_tr_b16 v[220:221], v237 offset:18560
    ds_read_b64_tr_b16 v[222:223], v237 offset:20096
    s_waitcnt lgkmcnt(12)
    v_mfma_f32_32x32x16_bf16 v[112:127], v[196:199], v[168:171], v[112:127]
    ds_read_b64_tr_b16 v[224:225], v236 offset:18688
    ds_read_b64_tr_b16 v[226:227], v236 offset:20224
    s_waitcnt lgkmcnt(12)
    v_mfma_f32_32x32x16_bf16 v[128:143], v[200:203], v[168:171], v[128:143]
    ds_read_b64_tr_b16 v[228:229], v237 offset:18688
    ds_read_b64_tr_b16 v[230:231], v237 offset:20224
    s_waitcnt lgkmcnt(12)
    v_mfma_f32_32x32x16_bf16 v[144:159], v[204:207], v[168:171], v[144:159]
    s_waitcnt lgkmcnt(10)
    v_mfma_f32_32x32x16_bf16 v[64:79], v[208:211], v[172:175], v[64:79]
    s_waitcnt lgkmcnt(8)
    v_mfma_f32_32x32x16_bf16 v[80:95], v[212:215], v[172:175], v[80:95]
    s_waitcnt lgkmcnt(6)
    v_mfma_f32_32x32x16_bf16 v[96:111], v[216:219], v[172:175], v[96:111]
    s_waitcnt lgkmcnt(4)
    v_mfma_f32_32x32x16_bf16 v[112:127], v[220:223], v[172:175], v[112:127]
    s_waitcnt lgkmcnt(2)
    v_mfma_f32_32x32x16_bf16 v[128:143], v[224:227], v[172:175], v[128:143]
    s_waitcnt lgkmcnt(0)
    v_mfma_f32_32x32x16_bf16 v[144:159], v[228:231], v[172:175], v[144:159]
    s_barrier
    v_add_u32 v236, 0, v10
    v_add_u32 v237, 0, v11
    s_waitcnt vmcnt(4)
    ds_read_b64_tr_b16 v[184:185], v236 offset:0
    ds_read_b64_tr_b16 v[186:187], v236 offset:1536
    ds_read_b64_tr_b16 v[188:189], v237 offset:0
    ds_read_b64_tr_b16 v[190:191], v237 offset:1536
    ds_read_b64_tr_b16 v[192:193], v236 offset:128
    ds_read_b64_tr_b16 v[194:195], v236 offset:1664
    ds_read_b64_tr_b16 v[196:197], v237 offset:128
    ds_read_b64_tr_b16 v[198:199], v237 offset:1664
    ds_read_b64_tr_b16 v[200:201], v236 offset:256
    ds_read_b64_tr_b16 v[202:203], v236 offset:1792
    ds_read_b64_tr_b16 v[204:205], v237 offset:256
    ds_read_b64_tr_b16 v[206:207], v237 offset:1792
    ds_read_b64_tr_b16 v[208:209], v236 offset:6144
    ds_read_b64_tr_b16 v[210:211], v236 offset:7680
    s_waitcnt lgkmcnt(12)
    v_mfma_f32_32x32x16_bf16 v[64:79], v[184:187], v[16:19], v[64:79]
    ds_read_b64_tr_b16 v[212:213], v237 offset:6144
    ds_read_b64_tr_b16 v[214:215], v237 offset:7680
    s_waitcnt lgkmcnt(12)
    v_mfma_f32_32x32x16_bf16 v[80:95], v[188:191], v[16:19], v[80:95]
    ds_read_b64_tr_b16 v[216:217], v236 offset:6272
    ds_read_b64_tr_b16 v[218:219], v236 offset:7808
    s_waitcnt lgkmcnt(12)
    v_mfma_f32_32x32x16_bf16 v[96:111], v[192:195], v[16:19], v[96:111]
    ds_read_b64_tr_b16 v[220:221], v237 offset:6272
    ds_read_b64_tr_b16 v[222:223], v237 offset:7808
    s_waitcnt lgkmcnt(12)
    v_mfma_f32_32x32x16_bf16 v[112:127], v[196:199], v[16:19], v[112:127]
    ds_read_b64_tr_b16 v[224:225], v236 offset:6400
    ds_read_b64_tr_b16 v[226:227], v236 offset:7936
    s_waitcnt lgkmcnt(12)
    v_mfma_f32_32x32x16_bf16 v[128:143], v[200:203], v[16:19], v[128:143]
    ds_read_b64_tr_b16 v[228:229], v237 offset:6400
    ds_read_b64_tr_b16 v[230:231], v237 offset:7936
    s_waitcnt lgkmcnt(12)
    v_mfma_f32_32x32x16_bf16 v[144:159], v[204:207], v[16:19], v[144:159]
    ds_read_b64_tr_b16 v[184:185], v236 offset:12288
    ds_read_b64_tr_b16 v[186:187], v236 offset:13824
    s_waitcnt lgkmcnt(12)
    v_mfma_f32_32x32x16_bf16 v[64:79], v[208:211], v[20:23], v[64:79]
    ds_read_b64_tr_b16 v[188:189], v237 offset:12288
    ds_read_b64_tr_b16 v[190:191], v237 offset:13824
    s_waitcnt lgkmcnt(12)
    v_mfma_f32_32x32x16_bf16 v[80:95], v[212:215], v[20:23], v[80:95]
    ds_read_b64_tr_b16 v[192:193], v236 offset:12416
    ds_read_b64_tr_b16 v[194:195], v236 offset:13952
    s_waitcnt lgkmcnt(12)
    v_mfma_f32_32x32x16_bf16 v[96:111], v[216:219], v[20:23], v[96:111]
    ds_read_b64_tr_b16 v[196:197], v237 offset:12416
    ds_read_b64_tr_b16 v[198:199], v237 offset:13952
    s_waitcnt lgkmcnt(12)
    v_mfma_f32_32x32x16_bf16 v[112:127], v[220:223], v[20:23], v[112:127]
    ds_read_b64_tr_b16 v[200:201], v236 offset:12544
    ds_read_b64_tr_b16 v[202:203], v236 offset:14080
    s_waitcnt lgkmcnt(12)
    v_mfma_f32_32x32x16_bf16 v[128:143], v[224:227], v[20:23], v[128:143]
    ds_read_b64_tr_b16 v[204:205], v237 offset:12544
    ds_read_b64_tr_b16 v[206:207], v237 offset:14080
    s_waitcnt lgkmcnt(12)
    v_mfma_f32_32x32x16_bf16 v[144:159], v[228:231], v[20:23], v[144:159]
    ds_read_b64_tr_b16 v[208:209], v236 offset:18432
    ds_read_b64_tr_b16 v[210:211], v236 offset:19968
    s_waitcnt lgkmcnt(12)
    v_mfma_f32_32x32x16_bf16 v[64:79], v[184:187], v[24:27], v[64:79]
    ds_read_b64_tr_b16 v[212:213], v237 offset:18432
    ds_read_b64_tr_b16 v[214:215], v237 offset:19968
    s_waitcnt lgkmcnt(12)
    v_mfma_f32_32x32x16_bf16 v[80:95], v[188:191], v[24:27], v[80:95]
    ds_read_b64_tr_b16 v[216:217], v236 offset:18560
    ds_read_b64_tr_b16 v[218:219], v236 offset:20096
    s_waitcnt lgkmcnt(12)
    v_mfma_f32_32x32x16_bf16 v[96:111], v[192:195], v[24:27], v[96:111]
    ds_read_b64_tr_b16 v[220:221], v237 offset:18560
    ds_read_b64_tr_b16 v[222:223], v237 offset:20096
    s_waitcnt lgkmcnt(12)
    v_mfma_f32_32x32x16_bf16 v[112:127], v[196:199], v[24:27], v[112:127]
    ds_read_b64_tr_b16 v[224:225], v236 offset:18688
    ds_read_b64_tr_b16 v[226:227], v236 offset:20224
    s_waitcnt lgkmcnt(12)
    v_mfma_f32_32x32x16_bf16 v[128:143], v[200:203], v[24:27], v[128:143]
    ds_read_b64_tr_b16 v[228:229], v237 offset:18688
    ds_read_b64_tr_b16 v[230:231], v237 offset:20224
    s_waitcnt lgkmcnt(12)
    v_mfma_f32_32x32x16_bf16 v[144:159], v[204:207], v[24:27], v[144:159]
    s_waitcnt lgkmcnt(10)
    v_mfma_f32_32x32x16_bf16 v[64:79], v[208:211], v[28:31], v[64:79]
    s_waitcnt lgkmcnt(8)
    v_mfma_f32_32x32x16_bf16 v[80:95], v[212:215], v[28:31], v[80:95]
    s_waitcnt lgkmcnt(6)
    v_mfma_f32_32x32x16_bf16 v[96:111], v[216:219], v[28:31], v[96:111]
    s_waitcnt lgkmcnt(4)
    v_mfma_f32_32x32x16_bf16 v[112:127], v[220:223], v[28:31], v[112:127]
    s_waitcnt lgkmcnt(2)
    v_mfma_f32_32x32x16_bf16 v[128:143], v[224:227], v[28:31], v[128:143]
    s_waitcnt lgkmcnt(0)
    v_mfma_f32_32x32x16_bf16 v[144:159], v[228:231], v[28:31], v[144:159]
    s_barrier
    v_add_u32 v236, 24576, v10
    v_add_u32 v237, 24576, v11
    s_waitcnt vmcnt(0)
    ds_read_b64_tr_b16 v[184:185], v236 offset:0
    ds_read_b64_tr_b16 v[186:187], v236 offset:1536
    ds_read_b64_tr_b16 v[188:189], v237 offset:0
    ds_read_b64_tr_b16 v[190:191], v237 offset:1536
    ds_read_b64_tr_b16 v[192:193], v236 offset:128
    ds_read_b64_tr_b16 v[194:195], v236 offset:1664
    ds_read_b64_tr_b16 v[196:197], v237 offset:128
    ds_read_b64_tr_b16 v[198:199], v237 offset:1664
    ds_read_b64_tr_b16 v[200:201], v236 offset:256
    ds_read_b64_tr_b16 v[202:203], v236 offset:1792
    ds_read_b64_tr_b16 v[204:205], v237 offset:256
    ds_read_b64_tr_b16 v[206:207], v237 offset:1792
    ds_read_b64_tr_b16 v[208:209], v236 offset:6144
    ds_read_b64_tr_b16 v[210:211], v236 offset:7680
    s_waitcnt lgkmcnt(12)
    v_mfma_f32_32x32x16_bf16 v[64:79], v[184:187], v[32:35], v[64:79]
    ds_read_b64_tr_b16 v[212:213], v237 offset:6144
    ds_read_b64_tr_b16 v[214:215], v237 offset:7680
    s_waitcnt lgkmcnt(12)
    v_mfma_f32_32x32x16_bf16 v[80:95], v[188:191], v[32:35], v[80:95]
    ds_read_b64_tr_b16 v[216:217], v236 offset:6272
    ds_read_b64_tr_b16 v[218:219], v236 offset:7808
    s_waitcnt lgkmcnt(12)
    v_mfma_f32_32x32x16_bf16 v[96:111], v[192:195], v[32:35], v[96:111]
    ds_read_b64_tr_b16 v[220:221], v237 offset:6272
    ds_read_b64_tr_b16 v[222:223], v237 offset:7808
    s_waitcnt lgkmcnt(12)
    v_mfma_f32_32x32x16_bf16 v[112:127], v[196:199], v[32:35], v[112:127]
    ds_read_b64_tr_b16 v[224:225], v236 offset:6400
    ds_read_b64_tr_b16 v[226:227], v236 offset:7936
    s_waitcnt lgkmcnt(12)
    v_mfma_f32_32x32x16_bf16 v[128:143], v[200:203], v[32:35], v[128:143]
    ds_read_b64_tr_b16 v[228:229], v237 offset:6400
    ds_read_b64_tr_b16 v[230:231], v237 offset:7936
    s_waitcnt lgkmcnt(12)
    v_mfma_f32_32x32x16_bf16 v[144:159], v[204:207], v[32:35], v[144:159]
    ds_read_b64_tr_b16 v[184:185], v236 offset:12288
    ds_read_b64_tr_b16 v[186:187], v236 offset:13824
    s_waitcnt lgkmcnt(12)
    v_mfma_f32_32x32x16_bf16 v[64:79], v[208:211], v[36:39], v[64:79]
    ds_read_b64_tr_b16 v[188:189], v237 offset:12288
    ds_read_b64_tr_b16 v[190:191], v237 offset:13824
    s_waitcnt lgkmcnt(12)
    v_mfma_f32_32x32x16_bf16 v[80:95], v[212:215], v[36:39], v[80:95]
    ds_read_b64_tr_b16 v[192:193], v236 offset:12416
    ds_read_b64_tr_b16 v[194:195], v236 offset:13952
    s_waitcnt lgkmcnt(12)
    v_mfma_f32_32x32x16_bf16 v[96:111], v[216:219], v[36:39], v[96:111]
    ds_read_b64_tr_b16 v[196:197], v237 offset:12416
    ds_read_b64_tr_b16 v[198:199], v237 offset:13952
    s_waitcnt lgkmcnt(12)
    v_mfma_f32_32x32x16_bf16 v[112:127], v[220:223], v[36:39], v[112:127]
    ds_read_b64_tr_b16 v[200:201], v236 offset:12544
    ds_read_b64_tr_b16 v[202:203], v236 offset:14080
    s_waitcnt lgkmcnt(12)
    v_mfma_f32_32x32x16_bf16 v[128:143], v[224:227], v[36:39], v[128:143]
    ds_read_b64_tr_b16 v[204:205], v237 offset:12544
    ds_read_b64_tr_b16 v[206:207], v237 offset:14080
    s_waitcnt lgkmcnt(12)
    v_mfma_f32_32x32x16_bf16 v[144:159], v[228:231], v[36:39], v[144:159]
    ds_read_b64_tr_b16 v[208:209], v236 offset:18432
    ds_read_b64_tr_b16 v[210:211], v236 offset:19968
    s_waitcnt lgkmcnt(12)
    v_mfma_f32_32x32x16_bf16 v[64:79], v[184:187], v[40:43], v[64:79]
    ds_read_b64_tr_b16 v[212:213], v237 offset:18432
    ds_read_b64_tr_b16 v[214:215], v237 offset:19968
    s_waitcnt lgkmcnt(12)
    v_mfma_f32_32x32x16_bf16 v[80:95], v[188:191], v[40:43], v[80:95]
    ds_read_b64_tr_b16 v[216:217], v236 offset:18560
    ds_read_b64_tr_b16 v[218:219], v236 offset:20096
    s_waitcnt lgkmcnt(12)
    v_mfma_f32_32x32x16_bf16 v[96:111], v[192:195], v[40:43], v[96:111]
    ds_read_b64_tr_b16 v[220:221], v237 offset:18560
    ds_read_b64_tr_b16 v[222:223], v237 offset:20096
    s_waitcnt lgkmcnt(12)
    v_mfma_f32_32x32x16_bf16 v[112:127], v[196:199], v[40:43], v[112:127]
    ds_read_b64_tr_b16 v[224:225], v236 offset:18688
    ds_read_b64_tr_b16 v[226:227], v236 offset:20224
    s_waitcnt lgkmcnt(12)
    v_mfma_f32_32x32x16_bf16 v[128:143], v[200:203], v[40:43], v[128:143]
    ds_read_b64_tr_b16 v[228:229], v237 offset:18688
    ds_read_b64_tr_b16 v[230:231], v237 offset:20224
    s_waitcnt lgkmcnt(12)
    v_mfma_f32_32x32x16_bf16 v[144:159], v[204:207], v[40:43], v[144:159]
    s_waitcnt lgkmcnt(10)
    v_mfma_f32_32x32x16_bf16 v[64:79], v[208:211], v[44:47], v[64:79]
    s_waitcnt lgkmcnt(8)
    v_mfma_f32_32x32x16_bf16 v[80:95], v[212:215], v[44:47], v[80:95]
    s_waitcnt lgkmcnt(6)
    v_mfma_f32_32x32x16_bf16 v[96:111], v[216:219], v[44:47], v[96:111]
    s_waitcnt lgkmcnt(4)
    v_mfma_f32_32x32x16_bf16 v[112:127], v[220:223], v[44:47], v[112:127]
    s_waitcnt lgkmcnt(2)
    v_mfma_f32_32x32x16_bf16 v[128:143], v[224:227], v[44:47], v[128:143]
    s_waitcnt lgkmcnt(0)
    v_mfma_f32_32x32x16_bf16 v[144:159], v[228:231], v[44:47], v[144:159]
    s_nop 15
    v_cvt_pk_bf16_f32 v16, v64, v65
    v_cvt_pk_bf16_f32 v17, v66, v67
    v_cvt_pk_bf16_f32 v18, v68, v69
    v_cvt_pk_bf16_f32 v19, v70, v71
    v_cvt_pk_bf16_f32 v20, v72, v73
    v_cvt_pk_bf16_f32 v21, v74, v75
    v_cvt_pk_bf16_f32 v22, v76, v77
    v_cvt_pk_bf16_f32 v23, v78, v79
    v_cvt_pk_bf16_f32 v24, v80, v81
    v_cvt_pk_bf16_f32 v25, v82, v83
    v_cvt_pk_bf16_f32 v26, v84, v85
    v_cvt_pk_bf16_f32 v27, v86, v87
    v_cvt_pk_bf16_f32 v28, v88, v89
    v_cvt_pk_bf16_f32 v29, v90, v91
    v_cvt_pk_bf16_f32 v30, v92, v93
    v_cvt_pk_bf16_f32 v31, v94, v95
    v_cvt_pk_bf16_f32 v32, v96, v97
    v_cvt_pk_bf16_f32 v33, v98, v99
    v_cvt_pk_bf16_f32 v34, v100, v101
    v_cvt_pk_bf16_f32 v35, v102, v103
    v_cvt_pk_bf16_f32 v36, v104, v105
    v_cvt_pk_bf16_f32 v37, v106, v107
    v_cvt_pk_bf16_f32 v38, v108, v109
    v_cvt_pk_bf16_f32 v39, v110, v111
    v_cvt_pk_bf16_f32 v40, v112, v113
    v_cvt_pk_bf16_f32 v41, v114, v115
    v_cvt_pk_bf16_f32 v42, v116, v117
    v_cvt_pk_bf16_f32 v43, v118, v119
    v_cvt_pk_bf16_f32 v44, v120, v121
    v_cvt_pk_bf16_f32 v45, v122, v123
    v_cvt_pk_bf16_f32 v46, v124, v125
    v_cvt_pk_bf16_f32 v47, v126, v127
    v_cvt_pk_bf16_f32 v48, v128, v129
    v_cvt_pk_bf16_f32 v49, v130, v131
    v_cvt_pk_bf16_f32 v50, v132, v133
    v_cvt_pk_bf16_f32 v51, v134, v135
    v_cvt_pk_bf16_f32 v52, v136, v137
    v_cvt_pk_bf16_f32 v53, v138, v139
    v_cvt_pk_bf16_f32 v54, v140, v141
    v_cvt_pk_bf16_f32 v55, v142, v143
    v_cvt_pk_bf16_f32 v56, v144, v145
    v_cvt_pk_bf16_f32 v57, v146, v147
    v_cvt_pk_bf16_f32 v58, v148, v149
    v_cvt_pk_bf16_f32 v59, v150, v151
    v_cvt_pk_bf16_f32 v60, v152, v153
    v_cvt_pk_bf16_f32 v61, v154, v155
    v_cvt_pk_bf16_f32 v62, v156, v157
    v_cvt_pk_bf16_f32 v63, v158, v159
    s_nop 1
    v_permlane32_swap_b32 v16, v18
    v_permlane32_swap_b32 v17, v19
    v_permlane32_swap_b32 v20, v22
    v_permlane32_swap_b32 v21, v23
    v_permlane32_swap_b32 v24, v26
    v_permlane32_swap_b32 v25, v27
    v_permlane32_swap_b32 v28, v30
    v_permlane32_swap_b32 v29, v31
    v_permlane32_swap_b32 v32, v34
    v_permlane32_swap_b32 v33, v35
    v_permlane32_swap_b32 v36, v38
    v_permlane32_swap_b32 v37, v39
    v_permlane32_swap_b32 v40, v42
    v_permlane32_swap_b32 v41, v43
    v_permlane32_swap_b32 v44, v46
    v_permlane32_swap_b32 v45, v47
    v_permlane32_swap_b32 v48, v50
    v_permlane32_swap_b32 v49, v51
    v_permlane32_swap_b32 v52, v54
    v_permlane32_swap_b32 v53, v55
    v_permlane32_swap_b32 v56, v58
    v_permlane32_swap_b32 v57, v59
    v_permlane32_swap_b32 v60, v62
    v_permlane32_swap_b32 v61, v63
    v_mov_b32 v64, 0
    v_mov_b32 v65, 0
    v_mov_b32 v66, 0
    v_mov_b32 v67, 0
    v_mov_b32 v68, 0
    v_mov_b32 v69, 0
    v_mov_b32 v70, 0
    v_mov_b32 v71, 0
    v_mov_b32 v72, 0
    v_mov_b32 v73, 0
    v_mov_b32 v74, 0
    v_mov_b32 v75, 0
    v_mov_b32 v76, 0
    v_mov_b32 v77, 0
    v_mov_b32 v78, 0
    v_mov_b32 v79, 0
    v_mov_b32 v80, 0
    v_mov_b32 v81, 0
    v_mov_b32 v82, 0
    v_mov_b32 v83, 0
    v_mov_b32 v84, 0
    v_mov_b32 v85, 0
    v_mov_b32 v86, 0
    v_mov_b32 v87, 0
    v_mov_b32 v88, 0
    v_mov_b32 v89, 0
    v_mov_b32 v90, 0
    v_mov_b32 v91, 0
    v_mov_b32 v92, 0
    v_mov_b32 v93, 0
    v_mov_b32 v94, 0
    v_mov_b32 v95, 0
    v_mov_b32 v96, 0
    v_mov_b32 v97, 0
    v_mov_b32 v98, 0
    v_mov_b32 v99, 0
    v_mov_b32 v100, 0
    v_mov_b32 v101, 0
    v_mov_b32 v102, 0
    v_mov_b32 v103, 0
    v_mov_b32 v104, 0
    v_mov_b32 v105, 0
    v_mov_b32 v106, 0
    v_mov_b32 v107, 0
    v_mov_b32 v108, 0
    v_mov_b32 v109, 0
    v_mov_b32 v110, 0
    v_mov_b32 v111, 0
    v_mov_b32 v112, 0
    v_mov_b32 v113, 0
    v_mov_b32 v114, 0
    v_mov_b32 v115, 0
    v_mov_b32 v116, 0
    v_mov_b32 v117, 0
    v_mov_b32 v118, 0
    v_mov_b32 v119, 0
    v_mov_b32 v120, 0
    v_mov_b32 v121, 0
    v_mov_b32 v122, 0
    v_mov_b32 v123, 0
    v_mov_b32 v124, 0
    v_mov_b32 v125, 0
    v_mov_b32 v126, 0
    v_mov_b32 v127, 0
    v_mov_b32 v128, 0
    v_mov_b32 v129, 0
    v_mov_b32 v130, 0
    v_mov_b32 v131, 0
    v_mov_b32 v132, 0
    v_mov_b32 v133, 0
    v_mov_b32 v134, 0
    v_mov_b32 v135, 0
    v_mov_b32 v136, 0
    v_mov_b32 v137, 0
    v_mov_b32 v138, 0
    v_mov_b32 v139, 0
    v_mov_b32 v140, 0
    v_mov_b32 v141, 0
    v_mov_b32 v142, 0
    v_mov_b32 v143, 0
    v_mov_b32 v144, 0
    v_mov_b32 v145, 0
    v_mov_b32 v146, 0
    v_mov_b32 v147, 0
    v_mov_b32 v148, 0
    v_mov_b32 v149, 0
    v_mov_b32 v150, 0
    v_mov_b32 v151, 0
    v_mov_b32 v152, 0
    v_mov_b32 v153, 0
    v_mov_b32 v154, 0
    v_mov_b32 v155, 0
    v_mov_b32 v156, 0
    v_mov_b32 v157, 0
    v_mov_b32 v158, 0
    v_mov_b32 v159, 0
    s_mov_b32 s48, 0
L1_kv_loop:
    s_barrier
    v_add_u32 v238, s47, v232
    v_add_u32 v239, s47, v233
    v_add_u32 v240, s47, v234
    v_add_u32 v241, s47, v235
    v_add_u32 v236, s47, v12
    v_add_u32 v237, s47, v13
    ds_read_b128 v[184:187], v238 offset:0
    ds_read_b128 v[188:191], v239 offset:0
    ds_read_b128 v[192:195], v240 offset:0
    ds_read_b128 v[196:199], v241 offset:0
    ds_read_b128 v[200:203], v238 offset:128
    ds_read_b128 v[204:207], v239 offset:128
    ds_read_b128 v[208:211], v240 offset:128
    ds_read_b128 v[212:215], v241 offset:128
    ds_read_b128 v[216:219], v238 offset:256
    ds_read_b128 v[220:223], v239 offset:256
    ds_read_b128 v[224:227], v240 offset:256
    ds_read_b128 v[228:231], v241 offset:256
    s_waitcnt lgkmcnt(11)
    v_mfma_f32_32x32x16_bf16 v[160:175], v[184:187], v[16:19], 0
    s_waitcnt lgkmcnt(10)
    v_mfma_f32_32x32x16_bf16 v[160:175], v[188:191], v[20:23], v[160:175]
    s_waitcnt lgkmcnt(9)
    v_mfma_f32_32x32x16_bf16 v[160:175], v[192:195], v[24:27], v[160:175]
    s_waitcnt lgkmcnt(8)
    v_mfma_f32_32x32x16_bf16 v[160:175], v[196:199], v[28:31], v[160:175]
    s_waitcnt lgkmcnt(7)
    v_mfma_f32_32x32x16_bf16 v[160:175], v[200:203], v[32:35], v[160:175]
    s_waitcnt lgkmcnt(6)
    v_mfma_f32_32x32x16_bf16 v[160:175], v[204:207], v[36:39], v[160:175]
    s_waitcnt lgkmcnt(5)
    v_mfma_f32_32x32x16_bf16 v[160:175], v[208:211], v[40:43], v[160:175]
    s_waitcnt lgkmcnt(4)
    v_mfma_f32_32x32x16_bf16 v[160:175], v[212:215], v[44:47], v[160:175]
    s_waitcnt lgkmcnt(3)
    v_mfma_f32_32x32x16_bf16 v[160:175], v[216:219], v[48:51], v[160:175]
    s_waitcnt lgkmcnt(2)
    v_mfma_f32_32x32x16_bf16 v[160:175], v[220:223], v[52:55], v[160:175]
    s_waitcnt lgkmcnt(1)
    v_mfma_f32_32x32x16_bf16 v[160:175], v[224:227], v[56:59], v[160:175]
    s_waitcnt lgkmcnt(0)
    v_mfma_f32_32x32x16_bf16 v[160:175], v[228:231], v[60:63], v[160:175]
    ds_read_b64_tr_b16 v[184:185], v236 offset:12288
    ds_read_b64_tr_b16 v[186:187], v236 offset:15360
    ds_read_b64_tr_b16 v[188:189], v237 offset:12288
    ds_read_b64_tr_b16 v[190:191], v237 offset:15360
    ds_read_b64_tr_b16 v[192:193], v236 offset:12416
    ds_read_b64_tr_b16 v[194:195], v236 offset:15488
    ds_read_b64_tr_b16 v[196:197], v237 offset:12416
    ds_read_b64_tr_b16 v[198:199], v237 offset:15488
    ds_read_b64_tr_b16 v[200:201], v236 offset:12544
    ds_read_b64_tr_b16 v[202:203], v236 offset:15616
    ds_read_b64_tr_b16 v[204:205], v237 offset:12544
    ds_read_b64_tr_b16 v[206:207], v237 offset:15616
    s_nop 3
    v_max3_f32 v247, v160, v161, v162
    v_max3_f32 v248, v163, v164, v165
    v_max3_f32 v247, v247, v166, v167
    v_max3_f32 v248, v248, v168, v169
    v_max3_f32 v247, v247, v170, v171
    v_max3_f32 v248, v248, v172, v173
    v_max3_f32 v247, v247, v174, v175
    v_max3_f32 v247, v247, v248, v242
    v_mov_b32 v248, v247
    s_nop 1
    v_permlane32_swap_b32 v247, v248
    s_nop 1
    v_max_f32 v247, v247, v248
    v_sub_f32 v248, v242, v247
    v_mul_f32 v248, s49, v248
    v_exp_f32 v244, v248
    v_mov_b32 v242, v247
    v_mul_f32 v246, s49, v247
    v_mov_b32 v245, v244
    v_fma_f32 v160, v160, s49, -v246
    v_fma_f32 v161, v161, s49, -v246
    v_fma_f32 v162, v162, s49, -v246
    v_fma_f32 v163, v163, s49, -v246
    v_fma_f32 v164, v164, s49, -v246
    v_fma_f32 v165, v165, s49, -v246
    v_fma_f32 v166, v166, s49, -v246
    v_fma_f32 v167, v167, s49, -v246
    v_fma_f32 v168, v168, s49, -v246
    v_fma_f32 v169, v169, s49, -v246
    v_fma_f32 v170, v170, s49, -v246
    v_fma_f32 v171, v171, s49, -v246
    v_fma_f32 v172, v172, s49, -v246
    v_fma_f32 v173, v173, s49, -v246
    v_fma_f32 v174, v174, s49, -v246
    v_fma_f32 v175, v175, s49, -v246
    v_exp_f32 v160, v160
    v_exp_f32 v161, v161
    v_exp_f32 v162, v162
    v_exp_f32 v163, v163
    v_exp_f32 v164, v164
    v_exp_f32 v165, v165
    v_exp_f32 v166, v166
    v_exp_f32 v167, v167
    v_exp_f32 v168, v168
    v_exp_f32 v169, v169
    v_exp_f32 v170, v170
    v_exp_f32 v171, v171
    v_exp_f32 v172, v172
    v_exp_f32 v173, v173
    v_exp_f32 v174, v174
    v_exp_f32 v175, v175
    v_pk_mul_f32 v[64:65], v[64:65], v[244:245]
    v_pk_mul_f32 v[66:67], v[66:67], v[244:245]
    v_pk_mul_f32 v[68:69], v[68:69], v[244:245]
    v_pk_mul_f32 v[70:71], v[70:71], v[244:245]
    v_pk_mul_f32 v[72:73], v[72:73], v[244:245]
    v_pk_mul_f32 v[74:75], v[74:75], v[244:245]
    v_pk_mul_f32 v[76:77], v[76:77], v[244:245]
    v_pk_mul_f32 v[78:79], v[78:79], v[244:245]
    v_pk_mul_f32 v[80:81], v[80:81], v[244:245]
    v_pk_mul_f32 v[82:83], v[82:83], v[244:245]
    v_pk_mul_f32 v[84:85], v[84:85], v[244:245]
    v_pk_mul_f32 v[86:87], v[86:87], v[244:245]
    v_pk_mul_f32 v[88:89], v[88:89], v[244:245]
    v_pk_mul_f32 v[90:91], v[90:91], v[244:245]
    v_pk_mul_f32 v[92:93], v[92:93], v[244:245]
    v_pk_mul_f32 v[94:95], v[94:95], v[244:245]
    v_pk_mul_f32 v[96:97], v[96:97], v[244:245]
    v_pk_mul_f32 v[98:99], v[98:99], v[244:245]
    v_pk_mul_f32 v[100:101], v[100:101], v[244:245]
    v_pk_mul_f32 v[102:103], v[102:103], v[244:245]
    v_pk_mul_f32 v[104:105], v[104:105], v[244:245]
    v_pk_mul_f32 v[106:107], v[106:107], v[244:245]
    v_pk_mul_f32 v[108:109], v[108:109], v[244:245]
    v_pk_mul_f32 v[110:111], v[110:111], v[244:245]
    v_pk_mul_f32 v[112:113], v[112:113], v[244:245]
    v_pk_mul_f32 v[114:115], v[114:115], v[244:245]
    v_pk_mul_f32 v[116:117], v[116:117], v[244:245]
    v_pk_mul_f32 v[118:119], v[118:119], v[244:245]
    v_pk_mul_f32 v[120:121], v[120:121], v[244:245]
    v_pk_mul_f32 v[122:123], v[122:123], v[244:245]
    v_pk_mul_f32 v[124:125], v[124:125], v[244:245]
    v_pk_mul_f32 v[126:127], v[126:127], v[244:245]
    v_pk_mul_f32 v[128:129], v[128:129], v[244:245]
    v_pk_mul_f32 v[130:131], v[130:131], v[244:245]
    v_pk_mul_f32 v[132:133], v[132:133], v[244:245]
    v_pk_mul_f32 v[134:135], v[134:135], v[244:245]
    v_pk_mul_f32 v[136:137], v[136:137], v[244:245]
    v_pk_mul_f32 v[138:139], v[138:139], v[244:245]
    v_pk_mul_f32 v[140:141], v[140:141], v[244:245]
    v_pk_mul_f32 v[142:143], v[142:143], v[244:245]
    v_pk_mul_f32 v[144:145], v[144:145], v[244:245]
    v_pk_mul_f32 v[146:147], v[146:147], v[244:245]
    v_pk_mul_f32 v[148:149], v[148:149], v[244:245]
    v_pk_mul_f32 v[150:151], v[150:151], v[244:245]
    v_pk_mul_f32 v[152:153], v[152:153], v[244:245]
    v_pk_mul_f32 v[154:155], v[154:155], v[244:245]
    v_pk_mul_f32 v[156:157], v[156:157], v[244:245]
    v_pk_mul_f32 v[158:159], v[158:159], v[244:245]
    v_add_f32 v249, v160, v161
    v_add_f32 v247, v162, v163
    v_add_f32 v249, v249, v164
    v_add_f32 v247, v247, v165
    v_add_f32 v249, v249, v166
    v_add_f32 v247, v247, v167
    v_add_f32 v249, v249, v168
    v_add_f32 v247, v247, v169
    v_add_f32 v249, v249, v170
    v_add_f32 v247, v247, v171
    v_add_f32 v249, v249, v172
    v_add_f32 v247, v247, v173
    v_add_f32 v249, v249, v174
    v_add_f32 v247, v247, v175
    v_add_f32 v249, v249, v247
    v_fma_f32 v243, v243, v244, v249
    v_cvt_pk_bf16_f32 v176, v160, v161
    v_cvt_pk_bf16_f32 v177, v162, v163
    v_cvt_pk_bf16_f32 v178, v164, v165
    v_cvt_pk_bf16_f32 v179, v166, v167
    v_cvt_pk_bf16_f32 v180, v168, v169
    v_cvt_pk_bf16_f32 v181, v170, v171
    v_cvt_pk_bf16_f32 v182, v172, v173
    v_cvt_pk_bf16_f32 v183, v174, v175
    s_nop 1
    ds_read_b64_tr_b16 v[208:209], v236 offset:18432
    ds_read_b64_tr_b16 v[210:211], v236 offset:21504
    s_waitcnt lgkmcnt(12)
    v_mfma_f32_32x32x16_bf16 v[64:79], v[184:187], v[176:179], v[64:79]
    ds_read_b64_tr_b16 v[212:213], v237 offset:18432
    ds_read_b64_tr_b16 v[214:215], v237 offset:21504
    s_waitcnt lgkmcnt(12)
    v_mfma_f32_32x32x16_bf16 v[80:95], v[188:191], v[176:179], v[80:95]
    ds_read_b64_tr_b16 v[216:217], v236 offset:18560
    ds_read_b64_tr_b16 v[218:219], v236 offset:21632
    s_waitcnt lgkmcnt(12)
    v_mfma_f32_32x32x16_bf16 v[96:111], v[192:195], v[176:179], v[96:111]
    ds_read_b64_tr_b16 v[220:221], v237 offset:18560
    ds_read_b64_tr_b16 v[222:223], v237 offset:21632
    s_waitcnt lgkmcnt(12)
    v_mfma_f32_32x32x16_bf16 v[112:127], v[196:199], v[176:179], v[112:127]
    ds_read_b64_tr_b16 v[224:225], v236 offset:18688
    ds_read_b64_tr_b16 v[226:227], v236 offset:21760
    s_waitcnt lgkmcnt(12)
    v_mfma_f32_32x32x16_bf16 v[128:143], v[200:203], v[176:179], v[128:143]
    ds_read_b64_tr_b16 v[228:229], v237 offset:18688
    ds_read_b64_tr_b16 v[230:231], v237 offset:21760
    s_waitcnt lgkmcnt(12)
    v_mfma_f32_32x32x16_bf16 v[144:159], v[204:207], v[176:179], v[144:159]
    s_waitcnt lgkmcnt(10)
    v_mfma_f32_32x32x16_bf16 v[64:79], v[208:211], v[180:183], v[64:79]
    s_waitcnt lgkmcnt(8)
    v_mfma_f32_32x32x16_bf16 v[80:95], v[212:215], v[180:183], v[80:95]
    s_waitcnt lgkmcnt(6)
    v_mfma_f32_32x32x16_bf16 v[96:111], v[216:219], v[180:183], v[96:111]
    s_waitcnt lgkmcnt(4)
    v_mfma_f32_32x32x16_bf16 v[112:127], v[220:223], v[180:183], v[112:127]
    s_waitcnt lgkmcnt(2)
    v_mfma_f32_32x32x16_bf16 v[128:143], v[224:227], v[180:183], v[128:143]
    s_waitcnt lgkmcnt(0)
    v_mfma_f32_32x32x16_bf16 v[144:159], v[228:231], v[180:183], v[144:159]
    s_mov_b32 s46, s47
    s_mov_b32 s47, s52
    s_mov_b32 s52, s53
    s_mov_b32 s53, s46
    s_add_u32 s48, s48, 1
    s_cmp_lt_u32 s48, 32
    s_cbranch_scc1 L1_kv_loop
    v_mov_b32 v248, v243
    s_nop 1
    v_permlane32_swap_b32 v243, v248
    s_nop 1
    v_add_f32 v243, v243, v248
    v_rcp_f32 v244, v243
    s_nop 7
    v_mov_b32 v245, v244
    v_pk_mul_f32 v[64:65], v[64:65], v[244:245]
    v_pk_mul_f32 v[66:67], v[66:67], v[244:245]
    v_pk_mul_f32 v[68:69], v[68:69], v[244:245]
    v_pk_mul_f32 v[70:71], v[70:71], v[244:245]
    v_pk_mul_f32 v[72:73], v[72:73], v[244:245]
    v_pk_mul_f32 v[74:75], v[74:75], v[244:245]
    v_pk_mul_f32 v[76:77], v[76:77], v[244:245]
    v_pk_mul_f32 v[78:79], v[78:79], v[244:245]
    v_pk_mul_f32 v[80:81], v[80:81], v[244:245]
    v_pk_mul_f32 v[82:83], v[82:83], v[244:245]
    v_pk_mul_f32 v[84:85], v[84:85], v[244:245]
    v_pk_mul_f32 v[86:87], v[86:87], v[244:245]
    v_pk_mul_f32 v[88:89], v[88:89], v[244:245]
    v_pk_mul_f32 v[90:91], v[90:91], v[244:245]
    v_pk_mul_f32 v[92:93], v[92:93], v[244:245]
    v_pk_mul_f32 v[94:95], v[94:95], v[244:245]
    v_pk_mul_f32 v[96:97], v[96:97], v[244:245]
    v_pk_mul_f32 v[98:99], v[98:99], v[244:245]
    v_pk_mul_f32 v[100:101], v[100:101], v[244:245]
    v_pk_mul_f32 v[102:103], v[102:103], v[244:245]
    v_pk_mul_f32 v[104:105], v[104:105], v[244:245]
    v_pk_mul_f32 v[106:107], v[106:107], v[244:245]
    v_pk_mul_f32 v[108:109], v[108:109], v[244:245]
    v_pk_mul_f32 v[110:111], v[110:111], v[244:245]
    v_pk_mul_f32 v[112:113], v[112:113], v[244:245]
    v_pk_mul_f32 v[114:115], v[114:115], v[244:245]
    v_pk_mul_f32 v[116:117], v[116:117], v[244:245]
    v_pk_mul_f32 v[118:119], v[118:119], v[244:245]
    v_pk_mul_f32 v[120:121], v[120:121], v[244:245]
    v_pk_mul_f32 v[122:123], v[122:123], v[244:245]
    v_pk_mul_f32 v[124:125], v[124:125], v[244:245]
    v_pk_mul_f32 v[126:127], v[126:127], v[244:245]
    v_pk_mul_f32 v[128:129], v[128:129], v[244:245]
    v_pk_mul_f32 v[130:131], v[130:131], v[244:245]
    v_pk_mul_f32 v[132:133], v[132:133], v[244:245]
    v_pk_mul_f32 v[134:135], v[134:135], v[244:245]
    v_pk_mul_f32 v[136:137], v[136:137], v[244:245]
    v_pk_mul_f32 v[138:139], v[138:139], v[244:245]
    v_pk_mul_f32 v[140:141], v[140:141], v[244:245]
    v_pk_mul_f32 v[142:143], v[142:143], v[244:245]
    v_pk_mul_f32 v[144:145], v[144:145], v[244:245]
    v_pk_mul_f32 v[146:147], v[146:147], v[244:245]
    v_pk_mul_f32 v[148:149], v[148:149], v[244:245]
    v_pk_mul_f32 v[150:151], v[150:151], v[244:245]
    v_pk_mul_f32 v[152:153], v[152:153], v[244:245]
    v_pk_mul_f32 v[154:155], v[154:155], v[244:245]
    v_pk_mul_f32 v[156:157], v[156:157], v[244:245]
    v_pk_mul_f32 v[158:159], v[158:159], v[244:245]
    v_cvt_pk_bf16_f32 v16, v64, v65
    v_cvt_pk_bf16_f32 v17, v66, v67
    v_cvt_pk_bf16_f32 v18, v68, v69
    v_cvt_pk_bf16_f32 v19, v70, v71
    v_cvt_pk_bf16_f32 v20, v72, v73
    v_cvt_pk_bf16_f32 v21, v74, v75
    v_cvt_pk_bf16_f32 v22, v76, v77
    v_cvt_pk_bf16_f32 v23, v78, v79
    v_cvt_pk_bf16_f32 v24, v80, v81
    v_cvt_pk_bf16_f32 v25, v82, v83
    v_cvt_pk_bf16_f32 v26, v84, v85
    v_cvt_pk_bf16_f32 v27, v86, v87
    v_cvt_pk_bf16_f32 v28, v88, v89
    v_cvt_pk_bf16_f32 v29, v90, v91
    v_cvt_pk_bf16_f32 v30, v92, v93
    v_cvt_pk_bf16_f32 v31, v94, v95
    v_cvt_pk_bf16_f32 v32, v96, v97
    v_cvt_pk_bf16_f32 v33, v98, v99
    v_cvt_pk_bf16_f32 v34, v100, v101
    v_cvt_pk_bf16_f32 v35, v102, v103
    v_cvt_pk_bf16_f32 v36, v104, v105
    v_cvt_pk_bf16_f32 v37, v106, v107
    v_cvt_pk_bf16_f32 v38, v108, v109
    v_cvt_pk_bf16_f32 v39, v110, v111
    v_cvt_pk_bf16_f32 v40, v112, v113
    v_cvt_pk_bf16_f32 v41, v114, v115
    v_cvt_pk_bf16_f32 v42, v116, v117
    v_cvt_pk_bf16_f32 v43, v118, v119
    v_cvt_pk_bf16_f32 v44, v120, v121
    v_cvt_pk_bf16_f32 v45, v122, v123
    v_cvt_pk_bf16_f32 v46, v124, v125
    v_cvt_pk_bf16_f32 v47, v126, v127
    v_cvt_pk_bf16_f32 v48, v128, v129
    v_cvt_pk_bf16_f32 v49, v130, v131
    v_cvt_pk_bf16_f32 v50, v132, v133
    v_cvt_pk_bf16_f32 v51, v134, v135
    v_cvt_pk_bf16_f32 v52, v136, v137
    v_cvt_pk_bf16_f32 v53, v138, v139
    v_cvt_pk_bf16_f32 v54, v140, v141
    v_cvt_pk_bf16_f32 v55, v142, v143
    v_cvt_pk_bf16_f32 v56, v144, v145
    v_cvt_pk_bf16_f32 v57, v146, v147
    v_cvt_pk_bf16_f32 v58, v148, v149
    v_cvt_pk_bf16_f32 v59, v150, v151
    v_cvt_pk_bf16_f32 v60, v152, v153
    v_cvt_pk_bf16_f32 v61, v154, v155
    v_cvt_pk_bf16_f32 v62, v156, v157
    v_cvt_pk_bf16_f32 v63, v158, v159
    s_nop 1
    v_permlane32_swap_b32 v16, v18
    v_permlane32_swap_b32 v17, v19
    v_permlane32_swap_b32 v20, v22
    v_permlane32_swap_b32 v21, v23
    v_permlane32_swap_b32 v24, v26
    v_permlane32_swap_b32 v25, v27
    v_permlane32_swap_b32 v28, v30
    v_permlane32_swap_b32 v29, v31
    v_permlane32_swap_b32 v32, v34
    v_permlane32_swap_b32 v33, v35
    v_permlane32_swap_b32 v36, v38
    v_permlane32_swap_b32 v37, v39
    v_permlane32_swap_b32 v40, v42
    v_permlane32_swap_b32 v41, v43
    v_permlane32_swap_b32 v44, v46
    v_permlane32_swap_b32 v45, v47
    v_permlane32_swap_b32 v48, v50
    v_permlane32_swap_b32 v49, v51
    v_permlane32_swap_b32 v52, v54
    v_permlane32_swap_b32 v53, v55
    v_permlane32_swap_b32 v56, v58
    v_permlane32_swap_b32 v57, v59
    v_permlane32_swap_b32 v60, v62
    v_permlane32_swap_b32 v61, v63
    s_nop 1
    s_mov_b32 s45, 4096
    s_mov_b32 s46, 8192
    buffer_store_dwordx4 v[16:19], v251, s[24:27], 0 offen offset:0
    buffer_store_dwordx4 v[20:23], v251, s[24:27], 0 offen offset:1024
    buffer_store_dwordx4 v[24:27], v251, s[24:27], 0 offen offset:2048
    buffer_store_dwordx4 v[28:31], v251, s[24:27], 0 offen offset:3072
    buffer_store_dwordx4 v[32:35], v251, s[24:27], s45 offen offset:0
    buffer_store_dwordx4 v[36:39], v251, s[24:27], s45 offen offset:1024
    buffer_store_dwordx4 v[40:43], v251, s[24:27], s45 offen offset:2048
    buffer_store_dwordx4 v[44:47], v251, s[24:27], s45 offen offset:3072
    buffer_store_dwordx4 v[48:51], v251, s[24:27], s46 offen offset:0
    buffer_store_dwordx4 v[52:55], v251, s[24:27], s46 offen offset:1024
    buffer_store_dwordx4 v[56:59], v251, s[24:27], s46 offen offset:2048
    buffer_store_dwordx4 v[60:63], v251, s[24:27], s46 offen offset:3072
L1_end:
    s_endpgm
.globl oproj_kernel
.p2align 8
.type oproj_kernel,@function
oproj_kernel:
    s_cmp_ge_u32 s2, 240
    s_cbranch_scc1 L2_end
    s_load_dwordx2 s[28:29], s[0:1], 32
    s_load_dwordx2 s[30:31], s[0:1], 56
    s_load_dwordx2 s[50:51], s[0:1], 48
    s_load_dwordx2 s[34:35], s[0:1], 40
    v_lshrrev_b32 v1, 6, v0
    v_and_b32 v2, 63, v0
    v_readfirstlane_b32 s40, v1
    s_and_b32 s38, s2, 3
    s_lshr_b32 s39, s2, 3
    s_bfe_u32 s41, s2, 0x10002
    s_mul_i32 s41, s41, 30
    s_add_u32 s39, s39, s41
    s_mul_i32 s41, s39, 0xcccd
    s_lshr_b32 s41, s41, 18
    s_mul_i32 s42, s41, 5
    s_sub_u32 s42, s39, s42
    s_waitcnt lgkmcnt(0)
    s_mov_b32 s8, s28
    s_and_b32 s9, s29, 0xffff
    s_mov_b32 s10, 7864320
    s_mov_b32 s11, 0x00020000
    s_mov_b32 s12, s30
    s_and_b32 s13, s31, 0xffff
    s_mov_b32 s14, 18874368
    s_mov_b32 s15, 0x00020000
    s_add_u32 s32, s30, 18874368
    s_addc_u32 s33, s31, 0
    s_mov_b32 s16, s32
    s_and_b32 s17, s33, 0xffff
    s_mov_b32 s18, 15728640
    s_mov_b32 s19, 0x00020000
    s_mov_b32 s20, s50
    s_and_b32 s21, s51, 0xffff
    s_mov_b32 s22, 256
    s_mov_b32 s23, 0x00020000
    s_mov_b32 s24, s34
    s_and_b32 s25, s35, 0xffff
    s_mov_b32 s26, 1966080
    s_mov_b32 s27, 0x00020000
    s_cmp_ge_u32 s40, 4
    s_cbranch_scc0 L2_compute
    v_lshrrev_b32 v3, 4, v2
    v_and_b32 v4, 15, v2
    v_lshlrev_b32 v5, 2, v3
    v_xor_b32 v4, v4, v5
    v_lshlrev_b32 v4, 4, v4
    v_mul_u32_u24 v5, 0x500, v3
    v_add_u32 v10, v4, v5
    s_sub_u32 s43, s40, 4
    s_mul_i32 s45, s38, 1966080
    s_lshl_b32 s46, s42, 8
    s_add_u32 s45, s45, s46
    s_mul_i32 s46, s43, 40960
    s_add_u32 s45, s45, s46
    s_lshl_b32 s44, s43, 13
    s_add_u32 m0, s44, 0
    s_nop 0
    buffer_load_dwordx4 v10, s[8:11], s45 offen  lds
    s_add_u32 m0, m0, 0x400
    s_add_u32 s45, s45, 5120
    buffer_load_dwordx4 v10, s[8:11], s45 offen  lds
    s_add_u32 m0, m0, 0x400
    s_add_u32 s45, s45, 5120
    buffer_load_dwordx4 v10, s[8:11], s45 offen  lds
    s_add_u32 m0, m0, 0x400
    s_add_u32 s45, s45, 5120
    buffer_load_dwordx4 v10, s[8:11], s45 offen  lds
    s_add_u32 m0, m0, 0x400
    s_add_u32 s45, s45, 5120
    buffer_load_dwordx4 v10, s[8:11], s45 offen  lds
    s_add_u32 m0, m0, 0x400
    s_add_u32 s45, s45, 5120
    buffer_load_dwordx4 v10, s[8:11], s45 offen  lds
    s_add_u32 m0, m0, 0x400
    s_add_u32 s45, s45, 5120
    buffer_load_dwordx4 v10, s[8:11], s45 offen  lds
    s_add_u32 m0, m0, 0x400
    s_add_u32 s45, s45, 5120
    buffer_load_dwordx4 v10, s[8:11], s45 offen  lds
    s_add_u32 m0, m0, 0x400
    s_add_u32 s45, s45, 46080
    s_add_u32 m0, s44, 16384
    s_nop 0
    buffer_load_dwordx4 v10, s[8:11], s45 offen  lds
    s_add_u32 m0, m0, 0x400
    s_add_u32 s45, s45, 5120
    buffer_load_dwordx4 v10, s[8:11], s45 offen  lds
    s_add_u32 m0, m0, 0x400
    s_add_u32 s45, s45, 5120
    buffer_load_dwordx4 v10, s[8:11], s45 offen  lds
    s_add_u32 m0, m0, 0x400
    s_add_u32 s45, s45, 5120
    buffer_load_dwordx4 v10, s[8:11], s45 offen  lds
    s_add_u32 m0, m0, 0x400
    s_add_u32 s45, s45, 5120
    buffer_load_dwordx4 v10, s[8:11], s45 offen  lds
    s_add_u32 m0, m0, 0x400
    s_add_u32 s45, s45, 5120
    buffer_load_dwordx4 v10, s[8:11], s45 offen  lds
    s_add_u32 m0, m0, 0x400
    s_add_u32 s45, s45, 5120
    buffer_load_dwordx4 v10, s[8:11], s45 offen  lds
    s_add_u32 m0, m0, 0x400
    s_add_u32 s45, s45, 5120
    buffer_load_dwordx4 v10, s[8:11], s45 offen  lds
    s_add_u32 m0, m0, 0x400
    s_add_u32 s45, s45, 46080
    s_add_u32 m0, s44, 32768
    s_nop 0
    buffer_load_dwordx4 v10, s[8:11], s45 offen  lds
    s_add_u32 m0, m0, 0x400
    s_add_u32 s45, s45, 5120
    buffer_load_dwordx4 v10, s[8:11], s45 offen  lds
    s_add_u32 m0, m0, 0x400
    s_add_u32 s45, s45, 5120
    buffer_load_dwordx4 v10, s[8:11], s45 offen  lds
    s_add_u32 m0, m0, 0x400
    s_add_u32 s45, s45, 5120
    buffer_load_dwordx4 v10, s[8:11], s45 offen  lds
    s_add_u32 m0, m0, 0x400
    s_add_u32 s45, s45, 5120
    buffer_load_dwordx4 v10, s[8:11], s45 offen  lds
    s_add_u32 m0, m0, 0x400
    s_add_u32 s45, s45, 5120
    buffer_load_dwordx4 v10, s[8:11], s45 offen  lds
    s_add_u32 m0, m0, 0x400
    s_add_u32 s45, s45, 5120
    buffer_load_dwordx4 v10, s[8:11], s45 offen  lds
    s_add_u32 m0, m0, 0x400
    s_add_u32 s45, s45, 5120
    buffer_load_dwordx4 v10, s[8:11], s45 offen  lds
    s_add_u32 m0, m0, 0x400
    s_add_u32 s45, s45, 46080
    s_add_u32 m0, s44, 49152
    s_nop 0
    buffer_load_dwordx4 v10, s[8:11], s45 offen  lds
    s_add_u32 m0, m0, 0x400
    s_add_u32 s45, s45, 5120
    buffer_load_dwordx4 v10, s[8:11], s45 offen  lds
    s_add_u32 m0, m0, 0x400
    s_add_u32 s45, s45, 5120
    buffer_load_dwordx4 v10, s[8:11], s45 offen  lds
    s_add_u32 m0, m0, 0x400
    s_add_u32 s45, s45, 5120
    buffer_load_dwordx4 v10, s[8:11], s45 offen  lds
    s_add_u32 m0, m0, 0x400
    s_add_u32 s45, s45, 5120
    buffer_load_dwordx4 v10, s[8:11], s45 offen  lds
    s_add_u32 m0, m0, 0x400
    s_add_u32 s45, s45, 5120
    buffer_load_dwordx4 v10, s[8:11], s45 offen  lds
    s_add_u32 m0, m0, 0x400
    s_add_u32 s45, s45, 5120
    buffer_load_dwordx4 v10, s[8:11], s45 offen  lds
    s_add_u32 m0, m0, 0x400
    s_add_u32 s45, s45, 5120
    buffer_load_dwordx4 v10, s[8:11], s45 offen  lds
    s_add_u32 m0, m0, 0x400
    s_add_u32 s45, s45, 46080
    s_add_u32 m0, s44, 65536
    s_nop 0
    buffer_load_dwordx4 v10, s[8:11], s45 offen  lds
    s_add_u32 m0, m0, 0x400
    s_add_u32 s45, s45, 5120
    buffer_load_dwordx4 v10, s[8:11], s45 offen  lds
    s_add_u32 m0, m0, 0x400
    s_add_u32 s45, s45, 5120
    buffer_load_dwordx4 v10, s[8:11], s45 offen  lds
    s_add_u32 m0, m0, 0x400
    s_add_u32 s45, s45, 5120
    buffer_load_dwordx4 v10, s[8:11], s45 offen  lds
    s_add_u32 m0, m0, 0x400
    s_add_u32 s45, s45, 5120
    buffer_load_dwordx4 v10, s[8:11], s45 offen  lds
    s_add_u32 m0, m0, 0x400
    s_add_u32 s45, s45, 5120
    buffer_load_dwordx4 v10, s[8:11], s45 offen  lds
    s_add_u32 m0, m0, 0x400
    s_add_u32 s45, s45, 5120
    buffer_load_dwordx4 v10, s[8:11], s45 offen  lds
    s_add_u32 m0, m0, 0x400
    s_add_u32 s45, s45, 5120
    buffer_load_dwordx4 v10, s[8:11], s45 offen  lds
    s_add_u32 m0, m0, 0x400
    s_add_u32 s45, s45, 46080
    s_add_u32 m0, s44, 81920
    s_nop 0
    buffer_load_dwordx4 v10, s[8:11], s45 offen  lds
    s_add_u32 m0, m0, 0x400
    s_add_u32 s45, s45, 5120
    buffer_load_dwordx4 v10, s[8:11], s45 offen  lds
    s_add_u32 m0, m0, 0x400
    s_add_u32 s45, s45, 5120
    buffer_load_dwordx4 v10, s[8:11], s45 offen  lds
    s_add_u32 m0, m0, 0x400
    s_add_u32 s45, s45, 5120
    buffer_load_dwordx4 v10, s[8:11], s45 offen  lds
    s_add_u32 m0, m0, 0x400
    s_add_u32 s45, s45, 5120
    buffer_load_dwordx4 v10, s[8:11], s45 offen  lds
    s_add_u32 m0, m0, 0x400
    s_add_u32 s45, s45, 5120
    buffer_load_dwordx4 v10, s[8:11], s45 offen  lds
    s_add_u32 m0, m0, 0x400
    s_add_u32 s45, s45, 5120
    buffer_load_dwordx4 v10, s[8:11], s45 offen  lds
    s_add_u32 m0, m0, 0x400
    s_add_u32 s45, s45, 5120
    buffer_load_dwordx4 v10, s[8:11], s45 offen  lds
    s_add_u32 m0, m0, 0x400
    s_add_u32 s45, s45, 46080
    s_waitcnt vmcnt(32)
    s_barrier
    s_add_u32 m0, s44, 98304
    s_nop 0
    buffer_load_dwordx4 v10, s[8:11], s45 offen  lds
    s_add_u32 m0, m0, 0x400
    s_add_u32 s45, s45, 5120
    buffer_load_dwordx4 v10, s[8:11], s45 offen  lds
    s_add_u32 m0, m0, 0x400
    s_add_u32 s45, s45, 5120
    buffer_load_dwordx4 v10, s[8:11], s45 offen  lds
    s_add_u32 m0, m0, 0x400
    s_add_u32 s45, s45, 5120
    buffer_load_dwordx4 v10, s[8:11], s45 offen  lds
    s_add_u32 m0, m0, 0x400
    s_add_u32 s45, s45, 5120
    buffer_load_dwordx4 v10, s[8:11], s45 offen  lds
    s_add_u32 m0, m0, 0x400
    s_add_u32 s45, s45, 5120
    buffer_load_dwordx4 v10, s[8:11], s45 offen  lds
    s_add_u32 m0, m0, 0x400
    s_add_u32 s45, s45, 5120
    buffer_load_dwordx4 v10, s[8:11], s45 offen  lds
    s_add_u32 m0, m0, 0x400
    s_add_u32 s45, s45, 5120
    buffer_load_dwordx4 v10, s[8:11], s45 offen  lds
    s_add_u32 m0, m0, 0x400
    s_add_u32 s45, s45, 46080
    s_add_u32 m0, s44, 114688
    s_nop 0
    buffer_load_dwordx4 v10, s[8:11], s45 offen  lds
    s_add_u32 m0, m0, 0x400
    s_add_u32 s45, s45, 5120
    buffer_load_dwordx4 v10, s[8:11], s45 offen  lds
    s_add_u32 m0, m0, 0x400
    s_add_u32 s45, s45, 5120
    buffer_load_dwordx4 v10, s[8:11], s45 offen  lds
    s_add_u32 m0, m0, 0x400
    s_add_u32 s45, s45, 5120
    buffer_load_dwordx4 v10, s[8:11], s45 offen  lds
    s_add_u32 m0, m0, 0x400
    s_add_u32 s45, s45, 5120
    buffer_load_dwordx4 v10, s[8:11], s45 offen  lds
    s_add_u32 m0, m0, 0x400
    s_add_u32 s45, s45, 5120
    buffer_load_dwordx4 v10, s[8:11], s45 offen  lds
    s_add_u32 m0, m0, 0x400
    s_add_u32 s45, s45, 5120
    buffer_load_dwordx4 v10, s[8:11], s45 offen  lds
    s_add_u32 m0, m0, 0x400
    s_add_u32 s45, s45, 5120
    buffer_load_dwordx4 v10, s[8:11], s45 offen  lds
    s_add_u32 m0, m0, 0x400
    s_add_u32 s45, s45, 46080
    s_waitcnt vmcnt(32)
    s_barrier
    s_add_u32 m0, s44, 0
    s_nop 0
    buffer_load_dwordx4 v10, s[8:11], s45 offen  lds
    s_add_u32 m0, m0, 0x400
    s_add_u32 s45, s45, 5120
    buffer_load_dwordx4 v10, s[8:11], s45 offen  lds
    s_add_u32 m0, m0, 0x400
    s_add_u32 s45, s45, 5120
    buffer_load_dwordx4 v10, s[8:11], s45 offen  lds
    s_add_u32 m0, m0, 0x400
    s_add_u32 s45, s45, 5120
    buffer_load_dwordx4 v10, s[8:11], s45 offen  lds
    s_add_u32 m0, m0, 0x400
    s_add_u32 s45, s45, 5120
    buffer_load_dwordx4 v10, s[8:11], s45 offen  lds
    s_add_u32 m0, m0, 0x400
    s_add_u32 s45, s45, 5120
    buffer_load_dwordx4 v10, s[8:11], s45 offen  lds
    s_add_u32 m0, m0, 0x400
    s_add_u32 s45, s45, 5120
    buffer_load_dwordx4 v10, s[8:11], s45 offen  lds
    s_add_u32 m0, m0, 0x400
    s_add_u32 s45, s45, 5120
    buffer_load_dwordx4 v10, s[8:11], s45 offen  lds
    s_add_u32 m0, m0, 0x400
    s_add_u32 s45, s45, 46080
    s_add_u32 m0, s44, 16384
    s_nop 0
    buffer_load_dwordx4 v10, s[8:11], s45 offen  lds
    s_add_u32 m0, m0, 0x400
    s_add_u32 s45, s45, 5120
    buffer_load_dwordx4 v10, s[8:11], s45 offen  lds
    s_add_u32 m0, m0, 0x400
    s_add_u32 s45, s45, 5120
    buffer_load_dwordx4 v10, s[8:11], s45 offen  lds
    s_add_u32 m0, m0, 0x400
    s_add_u32 s45, s45, 5120
    buffer_load_dwordx4 v10, s[8:11], s45 offen  lds
    s_add_u32 m0, m0, 0x400
    s_add_u32 s45, s45, 5120
    buffer_load_dwordx4 v10, s[8:11], s45 offen  lds
    s_add_u32 m0, m0, 0x400
    s_add_u32 s45, s45, 5120
    buffer_load_dwordx4 v10, s[8:11], s45 offen  lds
    s_add_u32 m0, m0, 0x400
    s_add_u32 s45, s45, 5120
    buffer_load_dwordx4 v10, s[8:11], s45 offen  lds
    s_add_u32 m0, m0, 0x400
    s_add_u32 s45, s45, 5120
    buffer_load_dwordx4 v10, s[8:11], s45 offen  lds
    s_add_u32 m0, m0, 0x400
    s_add_u32 s45, s45, 46080
    s_waitcnt vmcnt(32)
    s_barrier
    s_add_u32 m0, s44, 32768
    s_nop 0
    buffer_load_dwordx4 v10, s[8:11], s45 offen  lds
    s_add_u32 m0, m0, 0x400
    s_add_u32 s45, s45, 5120
    buffer_load_dwordx4 v10, s[8:11], s45 offen  lds
    s_add_u32 m0, m0, 0x400
    s_add_u32 s45, s45, 5120
    buffer_load_dwordx4 v10, s[8:11], s45 offen  lds
    s_add_u32 m0, m0, 0x400
    s_add_u32 s45, s45, 5120
    buffer_load_dwordx4 v10, s[8:11], s45 offen  lds
    s_add_u32 m0, m0, 0x400
    s_add_u32 s45, s45, 5120
    buffer_load_dwordx4 v10, s[8:11], s45 offen  lds
    s_add_u32 m0, m0, 0x400
    s_add_u32 s45, s45, 5120
    buffer_load_dwordx4 v10, s[8:11], s45 offen  lds
    s_add_u32 m0, m0, 0x400
    s_add_u32 s45, s45, 5120
    buffer_load_dwordx4 v10, s[8:11], s45 offen  lds
    s_add_u32 m0, m0, 0x400
    s_add_u32 s45, s45, 5120
    buffer_load_dwordx4 v10, s[8:11], s45 offen  lds
    s_add_u32 m0, m0, 0x400
    s_add_u32 s45, s45, 46080
    s_add_u32 m0, s44, 49152
    s_nop 0
    buffer_load_dwordx4 v10, s[8:11], s45 offen  lds
    s_add_u32 m0, m0, 0x400
    s_add_u32 s45, s45, 5120
    buffer_load_dwordx4 v10, s[8:11], s45 offen  lds
    s_add_u32 m0, m0, 0x400
    s_add_u32 s45, s45, 5120
    buffer_load_dwordx4 v10, s[8:11], s45 offen  lds
    s_add_u32 m0, m0, 0x400
    s_add_u32 s45, s45, 5120
    buffer_load_dwordx4 v10, s[8:11], s45 offen  lds
    s_add_u32 m0, m0, 0x400
    s_add_u32 s45, s45, 5120
    buffer_load_dwordx4 v10, s[8:11], s45 offen  lds
    s_add_u32 m0, m0, 0x400
    s_add_u32 s45, s45, 5120
    buffer_load_dwordx4 v10, s[8:11], s45 offen  lds
    s_add_u32 m0, m0, 0x400
    s_add_u32 s45, s45, 5120
    buffer_load_dwordx4 v10, s[8:11], s45 offen  lds
    s_add_u32 m0, m0, 0x400
    s_add_u32 s45, s45, 5120
    buffer_load_dwordx4 v10, s[8:11], s45 offen  lds
    s_add_u32 m0, m0, 0x400
    s_add_u32 s45, s45, 46080
    s_waitcnt vmcnt(32)
    s_barrier
    s_add_u32 m0, s44, 65536
    s_nop 0
    buffer_load_dwordx4 v10, s[8:11], s45 offen  lds
    s_add_u32 m0, m0, 0x400
    s_add_u32 s45, s45, 5120
    buffer_load_dwordx4 v10, s[8:11], s45 offen  lds
    s_add_u32 m0, m0, 0x400
    s_add_u32 s45, s45, 5120
    buffer_load_dwordx4 v10, s[8:11], s45 offen  lds
    s_add_u32 m0, m0, 0x400
    s_add_u32 s45, s45, 5120
    buffer_load_dwordx4 v10, s[8:11], s45 offen  lds
    s_add_u32 m0, m0, 0x400
    s_add_u32 s45, s45, 5120
    buffer_load_dwordx4 v10, s[8:11], s45 offen  lds
    s_add_u32 m0, m0, 0x400
    s_add_u32 s45, s45, 5120
    buffer_load_dwordx4 v10, s[8:11], s45 offen  lds
    s_add_u32 m0, m0, 0x400
    s_add_u32 s45, s45, 5120
    buffer_load_dwordx4 v10, s[8:11], s45 offen  lds
    s_add_u32 m0, m0, 0x400
    s_add_u32 s45, s45, 5120
    buffer_load_dwordx4 v10, s[8:11], s45 offen  lds
    s_add_u32 m0, m0, 0x400
    s_add_u32 s45, s45, 46080
    s_add_u32 m0, s44, 81920
    s_nop 0
    buffer_load_dwordx4 v10, s[8:11], s45 offen  lds
    s_add_u32 m0, m0, 0x400
    s_add_u32 s45, s45, 5120
    buffer_load_dwordx4 v10, s[8:11], s45 offen  lds
    s_add_u32 m0, m0, 0x400
    s_add_u32 s45, s45, 5120
    buffer_load_dwordx4 v10, s[8:11], s45 offen  lds
    s_add_u32 m0, m0, 0x400
    s_add_u32 s45, s45, 5120
    buffer_load_dwordx4 v10, s[8:11], s45 offen  lds
    s_add_u32 m0, m0, 0x400
    s_add_u32 s45, s45, 5120
    buffer_load_dwordx4 v10, s[8:11], s45 offen  lds
    s_add_u32 m0, m0, 0x400
    s_add_u32 s45, s45, 5120
    buffer_load_dwordx4 v10, s[8:11], s45 offen  lds
    s_add_u32 m0, m0, 0x400
    s_add_u32 s45, s45, 5120
    buffer_load_dwordx4 v10, s[8:11], s45 offen  lds
    s_add_u32 m0, m0, 0x400
    s_add_u32 s45, s45, 5120
    buffer_load_dwordx4 v10, s[8:11], s45 offen  lds
    s_add_u32 m0, m0, 0x400
    s_add_u32 s45, s45, 46080
    s_waitcnt vmcnt(32)
    s_barrier
    s_add_u32 m0, s44, 98304
    s_nop 0
    buffer_load_dwordx4 v10, s[8:11], s45 offen  lds
    s_add_u32 m0, m0, 0x400
    s_add_u32 s45, s45, 5120
    buffer_load_dwordx4 v10, s[8:11], s45 offen  lds
    s_add_u32 m0, m0, 0x400
    s_add_u32 s45, s45, 5120
    buffer_load_dwordx4 v10, s[8:11], s45 offen  lds
    s_add_u32 m0, m0, 0x400
    s_add_u32 s45, s45, 5120
    buffer_load_dwordx4 v10, s[8:11], s45 offen  lds
    s_add_u32 m0, m0, 0x400
    s_add_u32 s45, s45, 5120
    buffer_load_dwordx4 v10, s[8:11], s45 offen  lds
    s_add_u32 m0, m0, 0x400
    s_add_u32 s45, s45, 5120
    buffer_load_dwordx4 v10, s[8:11], s45 offen  lds
    s_add_u32 m0, m0, 0x400
    s_add_u32 s45, s45, 5120
    buffer_load_dwordx4 v10, s[8:11], s45 offen  lds
    s_add_u32 m0, m0, 0x400
    s_add_u32 s45, s45, 5120
    buffer_load_dwordx4 v10, s[8:11], s45 offen  lds
    s_add_u32 m0, m0, 0x400
    s_add_u32 s45, s45, 46080
    s_add_u32 m0, s44, 114688
    s_nop 0
    buffer_load_dwordx4 v10, s[8:11], s45 offen  lds
    s_add_u32 m0, m0, 0x400
    s_add_u32 s45, s45, 5120
    buffer_load_dwordx4 v10, s[8:11], s45 offen  lds
    s_add_u32 m0, m0, 0x400
    s_add_u32 s45, s45, 5120
    buffer_load_dwordx4 v10, s[8:11], s45 offen  lds
    s_add_u32 m0, m0, 0x400
    s_add_u32 s45, s45, 5120
    buffer_load_dwordx4 v10, s[8:11], s45 offen  lds
    s_add_u32 m0, m0, 0x400
    s_add_u32 s45, s45, 5120
    buffer_load_dwordx4 v10, s[8:11], s45 offen  lds
    s_add_u32 m0, m0, 0x400
    s_add_u32 s45, s45, 5120
    buffer_load_dwordx4 v10, s[8:11], s45 offen  lds
    s_add_u32 m0, m0, 0x400
    s_add_u32 s45, s45, 5120
    buffer_load_dwordx4 v10, s[8:11], s45 offen  lds
    s_add_u32 m0, m0, 0x400
    s_add_u32 s45, s45, 5120
    buffer_load_dwordx4 v10, s[8:11], s45 offen  lds
    s_add_u32 m0, m0, 0x400
    s_add_u32 s45, s45, 46080
    s_waitcnt vmcnt(32)
    s_barrier
    s_add_u32 m0, s44, 0
    s_nop 0
    buffer_load_dwordx4 v10, s[8:11], s45 offen  lds
    s_add_u32 m0, m0, 0x400
    s_add_u32 s45, s45, 5120
    buffer_load_dwordx4 v10, s[8:11], s45 offen  lds
    s_add_u32 m0, m0, 0x400
    s_add_u32 s45, s45, 5120
    buffer_load_dwordx4 v10, s[8:11], s45 offen  lds
    s_add_u32 m0, m0, 0x400
    s_add_u32 s45, s45, 5120
    buffer_load_dwordx4 v10, s[8:11], s45 offen  lds
    s_add_u32 m0, m0, 0x400
    s_add_u32 s45, s45, 5120
    buffer_load_dwordx4 v10, s[8:11], s45 offen  lds
    s_add_u32 m0, m0, 0x400
    s_add_u32 s45, s45, 5120
    buffer_load_dwordx4 v10, s[8:11], s45 offen  lds
    s_add_u32 m0, m0, 0x400
    s_add_u32 s45, s45, 5120
    buffer_load_dwordx4 v10, s[8:11], s45 offen  lds
    s_add_u32 m0, m0, 0x400
    s_add_u32 s45, s45, 5120
    buffer_load_dwordx4 v10, s[8:11], s45 offen  lds
    s_add_u32 m0, m0, 0x400
    s_add_u32 s45, s45, 46080
    s_add_u32 m0, s44, 16384
    s_nop 0
    buffer_load_dwordx4 v10, s[8:11], s45 offen  lds
    s_add_u32 m0, m0, 0x400
    s_add_u32 s45, s45, 5120
    buffer_load_dwordx4 v10, s[8:11], s45 offen  lds
    s_add_u32 m0, m0, 0x400
    s_add_u32 s45, s45, 5120
    buffer_load_dwordx4 v10, s[8:11], s45 offen  lds
    s_add_u32 m0, m0, 0x400
    s_add_u32 s45, s45, 5120
    buffer_load_dwordx4 v10, s[8:11], s45 offen  lds
    s_add_u32 m0, m0, 0x400
    s_add_u32 s45, s45, 5120
    buffer_load_dwordx4 v10, s[8:11], s45 offen  lds
    s_add_u32 m0, m0, 0x400
    s_add_u32 s45, s45, 5120
    buffer_load_dwordx4 v10, s[8:11], s45 offen  lds
    s_add_u32 m0, m0, 0x400
    s_add_u32 s45, s45, 5120
    buffer_load_dwordx4 v10, s[8:11], s45 offen  lds
    s_add_u32 m0, m0, 0x400
    s_add_u32 s45, s45, 5120
    buffer_load_dwordx4 v10, s[8:11], s45 offen  lds
    s_add_u32 m0, m0, 0x400
    s_add_u32 s45, s45, 46080
    s_waitcnt vmcnt(32)
    s_barrier
    s_add_u32 m0, s44, 32768
    s_nop 0
    buffer_load_dwordx4 v10, s[8:11], s45 offen  lds
    s_add_u32 m0, m0, 0x400
    s_add_u32 s45, s45, 5120
    buffer_load_dwordx4 v10, s[8:11], s45 offen  lds
    s_add_u32 m0, m0, 0x400
    s_add_u32 s45, s45, 5120
    buffer_load_dwordx4 v10, s[8:11], s45 offen  lds
    s_add_u32 m0, m0, 0x400
    s_add_u32 s45, s45, 5120
    buffer_load_dwordx4 v10, s[8:11], s45 offen  lds
    s_add_u32 m0, m0, 0x400
    s_add_u32 s45, s45, 5120
    buffer_load_dwordx4 v10, s[8:11], s45 offen  lds
    s_add_u32 m0, m0, 0x400
    s_add_u32 s45, s45, 5120
    buffer_load_dwordx4 v10, s[8:11], s45 offen  lds
    s_add_u32 m0, m0, 0x400
    s_add_u32 s45, s45, 5120
    buffer_load_dwordx4 v10, s[8:11], s45 offen  lds
    s_add_u32 m0, m0, 0x400
    s_add_u32 s45, s45, 5120
    buffer_load_dwordx4 v10, s[8:11], s45 offen  lds
    s_add_u32 m0, m0, 0x400
    s_add_u32 s45, s45, 46080
    s_add_u32 m0, s44, 49152
    s_nop 0
    buffer_load_dwordx4 v10, s[8:11], s45 offen  lds
    s_add_u32 m0, m0, 0x400
    s_add_u32 s45, s45, 5120
    buffer_load_dwordx4 v10, s[8:11], s45 offen  lds
    s_add_u32 m0, m0, 0x400
    s_add_u32 s45, s45, 5120
    buffer_load_dwordx4 v10, s[8:11], s45 offen  lds
    s_add_u32 m0, m0, 0x400
    s_add_u32 s45, s45, 5120
    buffer_load_dwordx4 v10, s[8:11], s45 offen  lds
    s_add_u32 m0, m0, 0x400
    s_add_u32 s45, s45, 5120
    buffer_load_dwordx4 v10, s[8:11], s45 offen  lds
    s_add_u32 m0, m0, 0x400
    s_add_u32 s45, s45, 5120
    buffer_load_dwordx4 v10, s[8:11], s45 offen  lds
    s_add_u32 m0, m0, 0x400
    s_add_u32 s45, s45, 5120
    buffer_load_dwordx4 v10, s[8:11], s45 offen  lds
    s_add_u32 m0, m0, 0x400
    s_add_u32 s45, s45, 5120
    buffer_load_dwordx4 v10, s[8:11], s45 offen  lds
    s_add_u32 m0, m0, 0x400
    s_add_u32 s45, s45, 46080
    s_waitcnt vmcnt(32)
    s_barrier
    s_add_u32 m0, s44, 65536
    s_nop 0
    buffer_load_dwordx4 v10, s[8:11], s45 offen  lds
    s_add_u32 m0, m0, 0x400
    s_add_u32 s45, s45, 5120
    buffer_load_dwordx4 v10, s[8:11], s45 offen  lds
    s_add_u32 m0, m0, 0x400
    s_add_u32 s45, s45, 5120
    buffer_load_dwordx4 v10, s[8:11], s45 offen  lds
    s_add_u32 m0, m0, 0x400
    s_add_u32 s45, s45, 5120
    buffer_load_dwordx4 v10, s[8:11], s45 offen  lds
    s_add_u32 m0, m0, 0x400
    s_add_u32 s45, s45, 5120
    buffer_load_dwordx4 v10, s[8:11], s45 offen  lds
    s_add_u32 m0, m0, 0x400
    s_add_u32 s45, s45, 5120
    buffer_load_dwordx4 v10, s[8:11], s45 offen  lds
    s_add_u32 m0, m0, 0x400
    s_add_u32 s45, s45, 5120
    buffer_load_dwordx4 v10, s[8:11], s45 offen  lds
    s_add_u32 m0, m0, 0x400
    s_add_u32 s45, s45, 5120
    buffer_load_dwordx4 v10, s[8:11], s45 offen  lds
    s_add_u32 m0, m0, 0x400
    s_add_u32 s45, s45, 46080
    s_add_u32 m0, s44, 81920
    s_nop 0
    buffer_load_dwordx4 v10, s[8:11], s45 offen  lds
    s_add_u32 m0, m0, 0x400
    s_add_u32 s45, s45, 5120
    buffer_load_dwordx4 v10, s[8:11], s45 offen  lds
    s_add_u32 m0, m0, 0x400
    s_add_u32 s45, s45, 5120
    buffer_load_dwordx4 v10, s[8:11], s45 offen  lds
    s_add_u32 m0, m0, 0x400
    s_add_u32 s45, s45, 5120
    buffer_load_dwordx4 v10, s[8:11], s45 offen  lds
    s_add_u32 m0, m0, 0x400
    s_add_u32 s45, s45, 5120
    buffer_load_dwordx4 v10, s[8:11], s45 offen  lds
    s_add_u32 m0, m0, 0x400
    s_add_u32 s45, s45, 5120
    buffer_load_dwordx4 v10, s[8:11], s45 offen  lds
    s_add_u32 m0, m0, 0x400
    s_add_u32 s45, s45, 5120
    buffer_load_dwordx4 v10, s[8:11], s45 offen  lds
    s_add_u32 m0, m0, 0x400
    s_add_u32 s45, s45, 5120
    buffer_load_dwordx4 v10, s[8:11], s45 offen  lds
    s_add_u32 m0, m0, 0x400
    s_add_u32 s45, s45, 46080
    s_waitcnt vmcnt(32)
    s_barrier
    s_add_u32 m0, s44, 98304
    s_nop 0
    buffer_load_dwordx4 v10, s[8:11], s45 offen  lds
    s_add_u32 m0, m0, 0x400
    s_add_u32 s45, s45, 5120
    buffer_load_dwordx4 v10, s[8:11], s45 offen  lds
    s_add_u32 m0, m0, 0x400
    s_add_u32 s45, s45, 5120
    buffer_load_dwordx4 v10, s[8:11], s45 offen  lds
    s_add_u32 m0, m0, 0x400
    s_add_u32 s45, s45, 5120
    buffer_load_dwordx4 v10, s[8:11], s45 offen  lds
    s_add_u32 m0, m0, 0x400
    s_add_u32 s45, s45, 5120
    buffer_load_dwordx4 v10, s[8:11], s45 offen  lds
    s_add_u32 m0, m0, 0x400
    s_add_u32 s45, s45, 5120
    buffer_load_dwordx4 v10, s[8:11], s45 offen  lds
    s_add_u32 m0, m0, 0x400
    s_add_u32 s45, s45, 5120
    buffer_load_dwordx4 v10, s[8:11], s45 offen  lds
    s_add_u32 m0, m0, 0x400
    s_add_u32 s45, s45, 5120
    buffer_load_dwordx4 v10, s[8:11], s45 offen  lds
    s_add_u32 m0, m0, 0x400
    s_add_u32 s45, s45, 46080
    s_add_u32 m0, s44, 114688
    s_nop 0
    buffer_load_dwordx4 v10, s[8:11], s45 offen  lds
    s_add_u32 m0, m0, 0x400
    s_add_u32 s45, s45, 5120
    buffer_load_dwordx4 v10, s[8:11], s45 offen  lds
    s_add_u32 m0, m0, 0x400
    s_add_u32 s45, s45, 5120
    buffer_load_dwordx4 v10, s[8:11], s45 offen  lds
    s_add_u32 m0, m0, 0x400
    s_add_u32 s45, s45, 5120
    buffer_load_dwordx4 v10, s[8:11], s45 offen  lds
    s_add_u32 m0, m0, 0x400
    s_add_u32 s45, s45, 5120
    buffer_load_dwordx4 v10, s[8:11], s45 offen  lds
    s_add_u32 m0, m0, 0x400
    s_add_u32 s45, s45, 5120
    buffer_load_dwordx4 v10, s[8:11], s45 offen  lds
    s_add_u32 m0, m0, 0x400
    s_add_u32 s45, s45, 5120
    buffer_load_dwordx4 v10, s[8:11], s45 offen  lds
    s_add_u32 m0, m0, 0x400
    s_add_u32 s45, s45, 5120
    buffer_load_dwordx4 v10, s[8:11], s45 offen  lds
    s_add_u32 m0, m0, 0x400
    s_add_u32 s45, s45, 46080
    s_waitcnt vmcnt(32)
    s_barrier
    s_waitcnt vmcnt(16)
    s_barrier
    s_waitcnt vmcnt(0)
    s_barrier
    s_endpgm
L2_compute:
    v_and_b32 v3, 15, v2
    v_lshrrev_b32 v4, 5, v2
    v_and_b32 v5, 31, v2
    v_lshrrev_b32 v6, 4, v2
    v_and_b32 v6, 1, v6
    v_lshrrev_b32 v7, 2, v3
    v_and_b32 v8, 3, v3
    v_lshlrev_b32 v8, 3, v8
    v_lshl_add_u32 v8, v6, 5, v8
    v_lshl_add_u32 v9, v4, 3, v7
    v_lshl_add_u32 v8, v9, 8, v8
    v_xor_b32 v9, 0, v7
    v_lshl_add_u32 v10, v9, 6, v8
    v_xor_b32 v9, 1, v7
    v_lshl_add_u32 v11, v9, 6, v8
    v_xor_b32 v9, 2, v7
    v_lshl_add_u32 v12, v9, 6, v8
    v_xor_b32 v9, 3, v7
    v_lshl_add_u32 v13, v9, 6, v8
    s_lshl_b32 s45, s41, 7
    s_lshl_b32 s46, s40, 5
    s_add_u32 s45, s45, s46
    v_add_u32 v9, s45, v5
    s_lshr_b32 s46, s45, 5
    s_mul_i32 s46, s46, 384
    s_mul_i32 s47, s38, 96
    s_add_u32 s46, s46, s47
    s_lshl_b32 s48, s46, 10
    v_lshlrev_b32 v14, 4, v2
    s_mul_i32 s46, s38, 3932160
    s_lshl_b32 s47, s39, 2
    s_add_u32 s47, s47, s40
    s_lshl_b32 s47, s47, 14
    s_add_u32 s46, s46, s47
    v_lshlrev_b32 v15, 4, v2
    v_add_u32 v15, s46, v15
    v_add_u32 v3, 0x10000, v10
    v_add_u32 v4, 0x10000, v11
    v_add_u32 v5, 0x10000, v12
    v_add_u32 v6, 0x10000, v13
    buffer_load_dwordx4 v[16:19], v14, s[12:15], s48 offen offset:0 nt
    buffer_load_dwordx4 v[20:23], v14, s[12:15], s48 offen offset:1024 nt
    buffer_load_dwordx4 v[24:27], v14, s[12:15], s48 offen offset:2048 nt
    buffer_load_dwordx4 v[28:31], v14, s[12:15], s48 offen offset:3072 nt
    s_add_u32 s48, s48, 4096
    buffer_load_dwordx4 v[32:35], v14, s[12:15], s48 offen offset:0 nt
    buffer_load_dwordx4 v[36:39], v14, s[12:15], s48 offen offset:1024 nt
    buffer_load_dwordx4 v[40:43], v14, s[12:15], s48 offen offset:2048 nt
    buffer_load_dwordx4 v[44:47], v14, s[12:15], s48 offen offset:3072 nt
    s_add_u32 s48, s48, 4096
    buffer_load_dwordx4 v[48:51], v14, s[12:15], s48 offen offset:0 nt
    buffer_load_dwordx4 v[52:55], v14, s[12:15], s48 offen offset:1024 nt
    buffer_load_dwordx4 v[56:59], v14, s[12:15], s48 offen offset:2048 nt
    buffer_load_dwordx4 v[60:63], v14, s[12:15], s48 offen offset:3072 nt
    s_add_u32 s48, s48, 4096
    buffer_load_dwordx4 v[64:67], v14, s[12:15], s48 offen offset:0 nt
    buffer_load_dwordx4 v[68:71], v14, s[12:15], s48 offen offset:1024 nt
    buffer_load_dwordx4 v[72:75], v14, s[12:15], s48 offen offset:2048 nt
    buffer_load_dwordx4 v[76:79], v14, s[12:15], s48 offen offset:3072 nt
    s_add_u32 s48, s48, 4096
    buffer_load_dwordx4 v[80:83], v14, s[12:15], s48 offen offset:0 nt
    buffer_load_dwordx4 v[84:87], v14, s[12:15], s48 offen offset:1024 nt
    buffer_load_dwordx4 v[88:91], v14, s[12:15], s48 offen offset:2048 nt
    buffer_load_dwordx4 v[92:95], v14, s[12:15], s48 offen offset:3072 nt
    s_add_u32 s48, s48, 4096
    buffer_load_dwordx4 v[96:99], v14, s[12:15], s48 offen offset:0 nt
    buffer_load_dwordx4 v[100:103], v14, s[12:15], s48 offen offset:1024 nt
    buffer_load_dwordx4 v[104:107], v14, s[12:15], s48 offen offset:2048 nt
    buffer_load_dwordx4 v[108:111], v14, s[12:15], s48 offen offset:3072 nt
    s_add_u32 s48, s48, 4096
    buffer_load_dwordx4 v[112:115], v14, s[12:15], s48 offen offset:0 nt
    buffer_load_dwordx4 v[116:119], v14, s[12:15], s48 offen offset:1024 nt
    buffer_load_dwordx4 v[120:123], v14, s[12:15], s48 offen offset:2048 nt
    buffer_load_dwordx4 v[124:127], v14, s[12:15], s48 offen offset:3072 nt
    s_add_u32 s48, s48, 4096
    s_barrier
    buffer_load_dwordx4 v[128:131], v14, s[12:15], s48 offen offset:0 nt
    buffer_load_dwordx4 v[132:135], v14, s[12:15], s48 offen offset:1024 nt
    buffer_load_dwordx4 v[136:139], v14, s[12:15], s48 offen offset:2048 nt
    buffer_load_dwordx4 v[140:143], v14, s[12:15], s48 offen offset:3072 nt
    s_add_u32 s48, s48, 4096
    s_waitcnt vmcnt(28)
    ds_read_b64_tr_b16 v[208:209], v10 offset:0
    ds_read_b64_tr_b16 v[210:211], v10 offset:1024
    ds_read_b64_tr_b16 v[212:213], v11 offset:0
    ds_read_b64_tr_b16 v[214:215], v11 offset:1024
    ds_read_b64_tr_b16 v[216:217], v12 offset:0
    ds_read_b64_tr_b16 v[218:219], v12 offset:1024
    ds_read_b64_tr_b16 v[220:221], v13 offset:0
    ds_read_b64_tr_b16 v[222:223], v13 offset:1024
    ds_read_b64_tr_b16 v[224:225], v10 offset:4096
    ds_read_b64_tr_b16 v[226:227], v10 offset:5120
    ds_read_b64_tr_b16 v[228:229], v11 offset:4096
    ds_read_b64_tr_b16 v[230:231], v11 offset:5120
    ds_read_b64_tr_b16 v[232:233], v12 offset:4096
    ds_read_b64_tr_b16 v[234:235], v12 offset:5120
    s_waitcnt lgkmcnt(12)
    v_mfma_f32_32x32x16_bf16 v[144:159], v[208:211], v[16:19], 0
    ds_read_b64_tr_b16 v[236:237], v13 offset:4096
    ds_read_b64_tr_b16 v[238:239], v13 offset:5120
    s_waitcnt lgkmcnt(12)
    v_mfma_f32_32x32x16_bf16 v[160:175], v[212:215], v[16:19], 0
    ds_read_b64_tr_b16 v[240:241], v10 offset:8192
    ds_read_b64_tr_b16 v[242:243], v10 offset:9216
    s_waitcnt lgkmcnt(12)
    v_mfma_f32_32x32x16_bf16 v[176:191], v[216:219], v[16:19], 0
    ds_read_b64_tr_b16 v[244:245], v11 offset:8192
    ds_read_b64_tr_b16 v[246:247], v11 offset:9216
    s_waitcnt lgkmcnt(12)
    v_mfma_f32_32x32x16_bf16 v[192:207], v[220:223], v[16:19], 0
    ds_read_b64_tr_b16 v[248:249], v12 offset:8192
    ds_read_b64_tr_b16 v[250:251], v12 offset:9216
    s_waitcnt lgkmcnt(12)
    v_mfma_f32_32x32x16_bf16 v[144:159], v[224:227], v[20:23], v[144:159]
    ds_read_b64_tr_b16 v[252:253], v13 offset:8192
    ds_read_b64_tr_b16 v[254:255], v13 offset:9216
    s_waitcnt lgkmcnt(12)
    v_mfma_f32_32x32x16_bf16 v[160:175], v[228:231], v[20:23], v[160:175]
    ds_read_b64_tr_b16 v[208:209], v10 offset:12288
    ds_read_b64_tr_b16 v[210:211], v10 offset:13312
    s_waitcnt lgkmcnt(12)
    v_mfma_f32_32x32x16_bf16 v[176:191], v[232:235], v[20:23], v[176:191]
    ds_read_b64_tr_b16 v[212:213], v11 offset:12288
    ds_read_b64_tr_b16 v[214:215], v11 offset:13312
    s_waitcnt lgkmcnt(12)
    v_mfma_f32_32x32x16_bf16 v[192:207], v[236:239], v[20:23], v[192:207]
    ds_read_b64_tr_b16 v[216:217], v12 offset:12288
    ds_read_b64_tr_b16 v[218:219], v12 offset:13312
    s_waitcnt lgkmcnt(12)
    v_mfma_f32_32x32x16_bf16 v[144:159], v[240:243], v[24:27], v[144:159]
    ds_read_b64_tr_b16 v[220:221], v13 offset:12288
    ds_read_b64_tr_b16 v[222:223], v13 offset:13312
    s_waitcnt lgkmcnt(12)
    v_mfma_f32_32x32x16_bf16 v[160:175], v[244:247], v[24:27], v[160:175]
    s_waitcnt lgkmcnt(10)
    v_mfma_f32_32x32x16_bf16 v[176:191], v[248:251], v[24:27], v[176:191]
    s_waitcnt lgkmcnt(8)
    v_mfma_f32_32x32x16_bf16 v[192:207], v[252:255], v[24:27], v[192:207]
    s_waitcnt lgkmcnt(6)
    v_mfma_f32_32x32x16_bf16 v[144:159], v[208:211], v[28:31], v[144:159]
    s_waitcnt lgkmcnt(4)
    v_mfma_f32_32x32x16_bf16 v[160:175], v[212:215], v[28:31], v[160:175]
    s_waitcnt lgkmcnt(2)
    v_mfma_f32_32x32x16_bf16 v[176:191], v[216:219], v[28:31], v[176:191]
    s_waitcnt lgkmcnt(0)
    v_mfma_f32_32x32x16_bf16 v[192:207], v[220:223], v[28:31], v[192:207]
    buffer_load_dwordx4 v[16:19], v14, s[12:15], s48 offen offset:0 nt
    buffer_load_dwordx4 v[20:23], v14, s[12:15], s48 offen offset:1024 nt
    buffer_load_dwordx4 v[24:27], v14, s[12:15], s48 offen offset:2048 nt
    buffer_load_dwordx4 v[28:31], v14, s[12:15], s48 offen offset:3072 nt
    s_add_u32 s48, s48, 4096
    s_waitcnt vmcnt(28)
    ds_read_b64_tr_b16 v[224:225], v10 offset:16384
    ds_read_b64_tr_b16 v[226:227], v10 offset:17408
    ds_read_b64_tr_b16 v[228:229], v11 offset:16384
    ds_read_b64_tr_b16 v[230:231], v11 offset:17408
    ds_read_b64_tr_b16 v[232:233], v12 offset:16384
    ds_read_b64_tr_b16 v[234:235], v12 offset:17408
    ds_read_b64_tr_b16 v[236:237], v13 offset:16384
    ds_read_b64_tr_b16 v[238:239], v13 offset:17408
    ds_read_b64_tr_b16 v[240:241], v10 offset:20480
    ds_read_b64_tr_b16 v[242:243], v10 offset:21504
    ds_read_b64_tr_b16 v[244:245], v11 offset:20480
    ds_read_b64_tr_b16 v[246:247], v11 offset:21504
    ds_read_b64_tr_b16 v[248:249], v12 offset:20480
    ds_read_b64_tr_b16 v[250:251], v12 offset:21504
    s_waitcnt lgkmcnt(12)
    v_mfma_f32_32x32x16_bf16 v[144:159], v[224:227], v[32:35], v[144:159]
    ds_read_b64_tr_b16 v[252:253], v13 offset:20480
    ds_read_b64_tr_b16 v[254:255], v13 offset:21504
    s_waitcnt lgkmcnt(12)
    v_mfma_f32_32x32x16_bf16 v[160:175], v[228:231], v[32:35], v[160:175]
    ds_read_b64_tr_b16 v[208:209], v10 offset:24576
    ds_read_b64_tr_b16 v[210:211], v10 offset:25600
    s_waitcnt lgkmcnt(12)
    v_mfma_f32_32x32x16_bf16 v[176:191], v[232:235], v[32:35], v[176:191]
    ds_read_b64_tr_b16 v[212:213], v11 offset:24576
    ds_read_b64_tr_b16 v[214:215], v11 offset:25600
    s_waitcnt lgkmcnt(12)
    v_mfma_f32_32x32x16_bf16 v[192:207], v[236:239], v[32:35], v[192:207]
    ds_read_b64_tr_b16 v[216:217], v12 offset:24576
    ds_read_b64_tr_b16 v[218:219], v12 offset:25600
    s_waitcnt lgkmcnt(12)
    v_mfma_f32_32x32x16_bf16 v[144:159], v[240:243], v[36:39], v[144:159]
    ds_read_b64_tr_b16 v[220:221], v13 offset:24576
    ds_read_b64_tr_b16 v[222:223], v13 offset:25600
    s_waitcnt lgkmcnt(12)
    v_mfma_f32_32x32x16_bf16 v[160:175], v[244:247], v[36:39], v[160:175]
    ds_read_b64_tr_b16 v[224:225], v10 offset:28672
    ds_read_b64_tr_b16 v[226:227], v10 offset:29696
    s_waitcnt lgkmcnt(12)
    v_mfma_f32_32x32x16_bf16 v[176:191], v[248:251], v[36:39], v[176:191]
    ds_read_b64_tr_b16 v[228:229], v11 offset:28672
    ds_read_b64_tr_b16 v[230:231], v11 offset:29696
    s_waitcnt lgkmcnt(12)
    v_mfma_f32_32x32x16_bf16 v[192:207], v[252:255], v[36:39], v[192:207]
    ds_read_b64_tr_b16 v[232:233], v12 offset:28672
    ds_read_b64_tr_b16 v[234:235], v12 offset:29696
    s_waitcnt lgkmcnt(12)
    v_mfma_f32_32x32x16_bf16 v[144:159], v[208:211], v[40:43], v[144:159]
    ds_read_b64_tr_b16 v[236:237], v13 offset:28672
    ds_read_b64_tr_b16 v[238:239], v13 offset:29696
    s_waitcnt lgkmcnt(12)
    v_mfma_f32_32x32x16_bf16 v[160:175], v[212:215], v[40:43], v[160:175]
    s_waitcnt lgkmcnt(10)
    v_mfma_f32_32x32x16_bf16 v[176:191], v[216:219], v[40:43], v[176:191]
    s_waitcnt lgkmcnt(8)
    v_mfma_f32_32x32x16_bf16 v[192:207], v[220:223], v[40:43], v[192:207]
    s_waitcnt lgkmcnt(6)
    v_mfma_f32_32x32x16_bf16 v[144:159], v[224:227], v[44:47], v[144:159]
    s_waitcnt lgkmcnt(4)
    v_mfma_f32_32x32x16_bf16 v[160:175], v[228:231], v[44:47], v[160:175]
    s_waitcnt lgkmcnt(2)
    v_mfma_f32_32x32x16_bf16 v[176:191], v[232:235], v[44:47], v[176:191]
    s_waitcnt lgkmcnt(0)
    v_mfma_f32_32x32x16_bf16 v[192:207], v[236:239], v[44:47], v[192:207]
    s_barrier
    buffer_load_dwordx4 v[32:35], v14, s[12:15], s48 offen offset:0 nt
    buffer_load_dwordx4 v[36:39], v14, s[12:15], s48 offen offset:1024 nt
    buffer_load_dwordx4 v[40:43], v14, s[12:15], s48 offen offset:2048 nt
    buffer_load_dwordx4 v[44:47], v14, s[12:15], s48 offen offset:3072 nt
    s_add_u32 s48, s48, 4096
    s_waitcnt vmcnt(28)
    ds_read_b64_tr_b16 v[240:241], v10 offset:32768
    ds_read_b64_tr_b16 v[242:243], v10 offset:33792
    ds_read_b64_tr_b16 v[244:245], v11 offset:32768
    ds_read_b64_tr_b16 v[246:247], v11 offset:33792
    ds_read_b64_tr_b16 v[248:249], v12 offset:32768
    ds_read_b64_tr_b16 v[250:251], v12 offset:33792
    ds_read_b64_tr_b16 v[252:253], v13 offset:32768
    ds_read_b64_tr_b16 v[254:255], v13 offset:33792
    ds_read_b64_tr_b16 v[208:209], v10 offset:36864
    ds_read_b64_tr_b16 v[210:211], v10 offset:37888
    ds_read_b64_tr_b16 v[212:213], v11 offset:36864
    ds_read_b64_tr_b16 v[214:215], v11 offset:37888
    ds_read_b64_tr_b16 v[216:217], v12 offset:36864
    ds_read_b64_tr_b16 v[218:219], v12 offset:37888
    s_waitcnt lgkmcnt(12)
    v_mfma_f32_32x32x16_bf16 v[144:159], v[240:243], v[48:51], v[144:159]
    ds_read_b64_tr_b16 v[220:221], v13 offset:36864
    ds_read_b64_tr_b16 v[222:223], v13 offset:37888
    s_waitcnt lgkmcnt(12)
    v_mfma_f32_32x32x16_bf16 v[160:175], v[244:247], v[48:51], v[160:175]
    ds_read_b64_tr_b16 v[224:225], v10 offset:40960
    ds_read_b64_tr_b16 v[226:227], v10 offset:41984
    s_waitcnt lgkmcnt(12)
    v_mfma_f32_32x32x16_bf16 v[176:191], v[248:251], v[48:51], v[176:191]
    ds_read_b64_tr_b16 v[228:229], v11 offset:40960
    ds_read_b64_tr_b16 v[230:231], v11 offset:41984
    s_waitcnt lgkmcnt(12)
    v_mfma_f32_32x32x16_bf16 v[192:207], v[252:255], v[48:51], v[192:207]
    ds_read_b64_tr_b16 v[232:233], v12 offset:40960
    ds_read_b64_tr_b16 v[234:235], v12 offset:41984
    s_waitcnt lgkmcnt(12)
    v_mfma_f32_32x32x16_bf16 v[144:159], v[208:211], v[52:55], v[144:159]
    ds_read_b64_tr_b16 v[236:237], v13 offset:40960
    ds_read_b64_tr_b16 v[238:239], v13 offset:41984
    s_waitcnt lgkmcnt(12)
    v_mfma_f32_32x32x16_bf16 v[160:175], v[212:215], v[52:55], v[160:175]
    ds_read_b64_tr_b16 v[240:241], v10 offset:45056
    ds_read_b64_tr_b16 v[242:243], v10 offset:46080
    s_waitcnt lgkmcnt(12)
    v_mfma_f32_32x32x16_bf16 v[176:191], v[216:219], v[52:55], v[176:191]
    ds_read_b64_tr_b16 v[244:245], v11 offset:45056
    ds_read_b64_tr_b16 v[246:247], v11 offset:46080
    s_waitcnt lgkmcnt(12)
    v_mfma_f32_32x32x16_bf16 v[192:207], v[220:223], v[52:55], v[192:207]
    ds_read_b64_tr_b16 v[248:249], v12 offset:45056
    ds_read_b64_tr_b16 v[250:251], v12 offset:46080
    s_waitcnt lgkmcnt(12)
    v_mfma_f32_32x32x16_bf16 v[144:159], v[224:227], v[56:59], v[144:159]
    ds_read_b64_tr_b16 v[252:253], v13 offset:45056
    ds_read_b64_tr_b16 v[254:255], v13 offset:46080
    s_waitcnt lgkmcnt(12)
    v_mfma_f32_32x32x16_bf16 v[160:175], v[228:231], v[56:59], v[160:175]
    s_waitcnt lgkmcnt(10)
    v_mfma_f32_32x32x16_bf16 v[176:191], v[232:235], v[56:59], v[176:191]
    s_waitcnt lgkmcnt(8)
    v_mfma_f32_32x32x16_bf16 v[192:207], v[236:239], v[56:59], v[192:207]
    s_waitcnt lgkmcnt(6)
    v_mfma_f32_32x32x16_bf16 v[144:159], v[240:243], v[60:63], v[144:159]
    s_waitcnt lgkmcnt(4)
    v_mfma_f32_32x32x16_bf16 v[160:175], v[244:247], v[60:63], v[160:175]
    s_waitcnt lgkmcnt(2)
    v_mfma_f32_32x32x16_bf16 v[176:191], v[248:251], v[60:63], v[176:191]
    s_waitcnt lgkmcnt(0)
    v_mfma_f32_32x32x16_bf16 v[192:207], v[252:255], v[60:63], v[192:207]
    buffer_load_dwordx4 v[48:51], v14, s[12:15], s48 offen offset:0 nt
    buffer_load_dwordx4 v[52:55], v14, s[12:15], s48 offen offset:1024 nt
    buffer_load_dwordx4 v[56:59], v14, s[12:15], s48 offen offset:2048 nt
    buffer_load_dwordx4 v[60:63], v14, s[12:15], s48 offen offset:3072 nt
    s_add_u32 s48, s48, 4096
    s_waitcnt vmcnt(28)
    ds_read_b64_tr_b16 v[208:209], v10 offset:49152
    ds_read_b64_tr_b16 v[210:211], v10 offset:50176
    ds_read_b64_tr_b16 v[212:213], v11 offset:49152
    ds_read_b64_tr_b16 v[214:215], v11 offset:50176
    ds_read_b64_tr_b16 v[216:217], v12 offset:49152
    ds_read_b64_tr_b16 v[218:219], v12 offset:50176
    ds_read_b64_tr_b16 v[220:221], v13 offset:49152
    ds_read_b64_tr_b16 v[222:223], v13 offset:50176
    ds_read_b64_tr_b16 v[224:225], v10 offset:53248
    ds_read_b64_tr_b16 v[226:227], v10 offset:54272
    ds_read_b64_tr_b16 v[228:229], v11 offset:53248
    ds_read_b64_tr_b16 v[230:231], v11 offset:54272
    ds_read_b64_tr_b16 v[232:233], v12 offset:53248
    ds_read_b64_tr_b16 v[234:235], v12 offset:54272
    s_waitcnt lgkmcnt(12)
    v_mfma_f32_32x32x16_bf16 v[144:159], v[208:211], v[64:67], v[144:159]
    ds_read_b64_tr_b16 v[236:237], v13 offset:53248
    ds_read_b64_tr_b16 v[238:239], v13 offset:54272
    s_waitcnt lgkmcnt(12)
    v_mfma_f32_32x32x16_bf16 v[160:175], v[212:215], v[64:67], v[160:175]
    ds_read_b64_tr_b16 v[240:241], v10 offset:57344
    ds_read_b64_tr_b16 v[242:243], v10 offset:58368
    s_waitcnt lgkmcnt(12)
    v_mfma_f32_32x32x16_bf16 v[176:191], v[216:219], v[64:67], v[176:191]
    ds_read_b64_tr_b16 v[244:245], v11 offset:57344
    ds_read_b64_tr_b16 v[246:247], v11 offset:58368
    s_waitcnt lgkmcnt(12)
    v_mfma_f32_32x32x16_bf16 v[192:207], v[220:223], v[64:67], v[192:207]
    ds_read_b64_tr_b16 v[248:249], v12 offset:57344
    ds_read_b64_tr_b16 v[250:251], v12 offset:58368
    s_waitcnt lgkmcnt(12)
    v_mfma_f32_32x32x16_bf16 v[144:159], v[224:227], v[68:71], v[144:159]
    ds_read_b64_tr_b16 v[252:253], v13 offset:57344
    ds_read_b64_tr_b16 v[254:255], v13 offset:58368
    s_waitcnt lgkmcnt(12)
    v_mfma_f32_32x32x16_bf16 v[160:175], v[228:231], v[68:71], v[160:175]
    ds_read_b64_tr_b16 v[208:209], v10 offset:61440
    ds_read_b64_tr_b16 v[210:211], v10 offset:62464
    s_waitcnt lgkmcnt(12)
    v_mfma_f32_32x32x16_bf16 v[176:191], v[232:235], v[68:71], v[176:191]
    ds_read_b64_tr_b16 v[212:213], v11 offset:61440
    ds_read_b64_tr_b16 v[214:215], v11 offset:62464
    s_waitcnt lgkmcnt(12)
    v_mfma_f32_32x32x16_bf16 v[192:207], v[236:239], v[68:71], v[192:207]
    ds_read_b64_tr_b16 v[216:217], v12 offset:61440
    ds_read_b64_tr_b16 v[218:219], v12 offset:62464
    s_waitcnt lgkmcnt(12)
    v_mfma_f32_32x32x16_bf16 v[144:159], v[240:243], v[72:75], v[144:159]
    ds_read_b64_tr_b16 v[220:221], v13 offset:61440
    ds_read_b64_tr_b16 v[222:223], v13 offset:62464
    s_waitcnt lgkmcnt(12)
    v_mfma_f32_32x32x16_bf16 v[160:175], v[244:247], v[72:75], v[160:175]
    s_waitcnt lgkmcnt(10)
    v_mfma_f32_32x32x16_bf16 v[176:191], v[248:251], v[72:75], v[176:191]
    s_waitcnt lgkmcnt(8)
    v_mfma_f32_32x32x16_bf16 v[192:207], v[252:255], v[72:75], v[192:207]
    s_waitcnt lgkmcnt(6)
    v_mfma_f32_32x32x16_bf16 v[144:159], v[208:211], v[76:79], v[144:159]
    s_waitcnt lgkmcnt(4)
    v_mfma_f32_32x32x16_bf16 v[160:175], v[212:215], v[76:79], v[160:175]
    s_waitcnt lgkmcnt(2)
    v_mfma_f32_32x32x16_bf16 v[176:191], v[216:219], v[76:79], v[176:191]
    s_waitcnt lgkmcnt(0)
    v_mfma_f32_32x32x16_bf16 v[192:207], v[220:223], v[76:79], v[192:207]
    s_barrier
    buffer_load_dwordx4 v[64:67], v14, s[12:15], s48 offen offset:0 nt
    buffer_load_dwordx4 v[68:71], v14, s[12:15], s48 offen offset:1024 nt
    buffer_load_dwordx4 v[72:75], v14, s[12:15], s48 offen offset:2048 nt
    buffer_load_dwordx4 v[76:79], v14, s[12:15], s48 offen offset:3072 nt
    s_add_u32 s48, s48, 4096
    s_waitcnt vmcnt(28)
    ds_read_b64_tr_b16 v[224:225], v3 offset:0
    ds_read_b64_tr_b16 v[226:227], v3 offset:1024
    ds_read_b64_tr_b16 v[228:229], v4 offset:0
    ds_read_b64_tr_b16 v[230:231], v4 offset:1024
    ds_read_b64_tr_b16 v[232:233], v5 offset:0
    ds_read_b64_tr_b16 v[234:235], v5 offset:1024
    ds_read_b64_tr_b16 v[236:237], v6 offset:0
    ds_read_b64_tr_b16 v[238:239], v6 offset:1024
    ds_read_b64_tr_b16 v[240:241], v3 offset:4096
    ds_read_b64_tr_b16 v[242:243], v3 offset:5120
    ds_read_b64_tr_b16 v[244:245], v4 offset:4096
    ds_read_b64_tr_b16 v[246:247], v4 offset:5120
    ds_read_b64_tr_b16 v[248:249], v5 offset:4096
    ds_read_b64_tr_b16 v[250:251], v5 offset:5120
    s_waitcnt lgkmcnt(12)
    v_mfma_f32_32x32x16_bf16 v[144:159], v[224:227], v[80:83], v[144:159]
    ds_read_b64_tr_b16 v[252:253], v6 offset:4096
    ds_read_b64_tr_b16 v[254:255], v6 offset:5120
    s_waitcnt lgkmcnt(12)
    v_mfma_f32_32x32x16_bf16 v[160:175], v[228:231], v[80:83], v[160:175]
    ds_read_b64_tr_b16 v[208:209], v3 offset:8192
    ds_read_b64_tr_b16 v[210:211], v3 offset:9216
    s_waitcnt lgkmcnt(12)
    v_mfma_f32_32x32x16_bf16 v[176:191], v[232:235], v[80:83], v[176:191]
    ds_read_b64_tr_b16 v[212:213], v4 offset:8192
    ds_read_b64_tr_b16 v[214:215], v4 offset:9216
    s_waitcnt lgkmcnt(12)
    v_mfma_f32_32x32x16_bf16 v[192:207], v[236:239], v[80:83], v[192:207]
    ds_read_b64_tr_b16 v[216:217], v5 offset:8192
    ds_read_b64_tr_b16 v[218:219], v5 offset:9216
    s_waitcnt lgkmcnt(12)
    v_mfma_f32_32x32x16_bf16 v[144:159], v[240:243], v[84:87], v[144:159]
    ds_read_b64_tr_b16 v[220:221], v6 offset:8192
    ds_read_b64_tr_b16 v[222:223], v6 offset:9216
    s_waitcnt lgkmcnt(12)
    v_mfma_f32_32x32x16_bf16 v[160:175], v[244:247], v[84:87], v[160:175]
    ds_read_b64_tr_b16 v[224:225], v3 offset:12288
    ds_read_b64_tr_b16 v[226:227], v3 offset:13312
    s_waitcnt lgkmcnt(12)
    v_mfma_f32_32x32x16_bf16 v[176:191], v[248:251], v[84:87], v[176:191]
    ds_read_b64_tr_b16 v[228:229], v4 offset:12288
    ds_read_b64_tr_b16 v[230:231], v4 offset:13312
    s_waitcnt lgkmcnt(12)
    v_mfma_f32_32x32x16_bf16 v[192:207], v[252:255], v[84:87], v[192:207]
    ds_read_b64_tr_b16 v[232:233], v5 offset:12288
    ds_read_b64_tr_b16 v[234:235], v5 offset:13312
    s_waitcnt lgkmcnt(12)
    v_mfma_f32_32x32x16_bf16 v[144:159], v[208:211], v[88:91], v[144:159]
    ds_read_b64_tr_b16 v[236:237], v6 offset:12288
    ds_read_b64_tr_b16 v[238:239], v6 offset:13312
    s_waitcnt lgkmcnt(12)
    v_mfma_f32_32x32x16_bf16 v[160:175], v[212:215], v[88:91], v[160:175]
    s_waitcnt lgkmcnt(10)
    v_mfma_f32_32x32x16_bf16 v[176:191], v[216:219], v[88:91], v[176:191]
    s_waitcnt lgkmcnt(8)
    v_mfma_f32_32x32x16_bf16 v[192:207], v[220:223], v[88:91], v[192:207]
    s_waitcnt lgkmcnt(6)
    v_mfma_f32_32x32x16_bf16 v[144:159], v[224:227], v[92:95], v[144:159]
    s_waitcnt lgkmcnt(4)
    v_mfma_f32_32x32x16_bf16 v[160:175], v[228:231], v[92:95], v[160:175]
    s_waitcnt lgkmcnt(2)
    v_mfma_f32_32x32x16_bf16 v[176:191], v[232:235], v[92:95], v[176:191]
    s_waitcnt lgkmcnt(0)
    v_mfma_f32_32x32x16_bf16 v[192:207], v[236:239], v[92:95], v[192:207]
    buffer_load_dwordx4 v[80:83], v14, s[12:15], s48 offen offset:0 nt
    buffer_load_dwordx4 v[84:87], v14, s[12:15], s48 offen offset:1024 nt
    buffer_load_dwordx4 v[88:91], v14, s[12:15], s48 offen offset:2048 nt
    buffer_load_dwordx4 v[92:95], v14, s[12:15], s48 offen offset:3072 nt
    s_add_u32 s48, s48, 4096
    s_waitcnt vmcnt(28)
    ds_read_b64_tr_b16 v[240:241], v3 offset:16384
    ds_read_b64_tr_b16 v[242:243], v3 offset:17408
    ds_read_b64_tr_b16 v[244:245], v4 offset:16384
    ds_read_b64_tr_b16 v[246:247], v4 offset:17408
    ds_read_b64_tr_b16 v[248:249], v5 offset:16384
    ds_read_b64_tr_b16 v[250:251], v5 offset:17408
    ds_read_b64_tr_b16 v[252:253], v6 offset:16384
    ds_read_b64_tr_b16 v[254:255], v6 offset:17408
    ds_read_b64_tr_b16 v[208:209], v3 offset:20480
    ds_read_b64_tr_b16 v[210:211], v3 offset:21504
    ds_read_b64_tr_b16 v[212:213], v4 offset:20480
    ds_read_b64_tr_b16 v[214:215], v4 offset:21504
    ds_read_b64_tr_b16 v[216:217], v5 offset:20480
    ds_read_b64_tr_b16 v[218:219], v5 offset:21504
    s_waitcnt lgkmcnt(12)
    v_mfma_f32_32x32x16_bf16 v[144:159], v[240:243], v[96:99], v[144:159]
    ds_read_b64_tr_b16 v[220:221], v6 offset:20480
    ds_read_b64_tr_b16 v[222:223], v6 offset:21504
    s_waitcnt lgkmcnt(12)
    v_mfma_f32_32x32x16_bf16 v[160:175], v[244:247], v[96:99], v[160:175]
    ds_read_b64_tr_b16 v[224:225], v3 offset:24576
    ds_read_b64_tr_b16 v[226:227], v3 offset:25600
    s_waitcnt lgkmcnt(12)
    v_mfma_f32_32x32x16_bf16 v[176:191], v[248:251], v[96:99], v[176:191]
    ds_read_b64_tr_b16 v[228:229], v4 offset:24576
    ds_read_b64_tr_b16 v[230:231], v4 offset:25600
    s_waitcnt lgkmcnt(12)
    v_mfma_f32_32x32x16_bf16 v[192:207], v[252:255], v[96:99], v[192:207]
    ds_read_b64_tr_b16 v[232:233], v5 offset:24576
    ds_read_b64_tr_b16 v[234:235], v5 offset:25600
    s_waitcnt lgkmcnt(12)
    v_mfma_f32_32x32x16_bf16 v[144:159], v[208:211], v[100:103], v[144:159]
    ds_read_b64_tr_b16 v[236:237], v6 offset:24576
    ds_read_b64_tr_b16 v[238:239], v6 offset:25600
    s_waitcnt lgkmcnt(12)
    v_mfma_f32_32x32x16_bf16 v[160:175], v[212:215], v[100:103], v[160:175]
    ds_read_b64_tr_b16 v[240:241], v3 offset:28672
    ds_read_b64_tr_b16 v[242:243], v3 offset:29696
    s_waitcnt lgkmcnt(12)
    v_mfma_f32_32x32x16_bf16 v[176:191], v[216:219], v[100:103], v[176:191]
    ds_read_b64_tr_b16 v[244:245], v4 offset:28672
    ds_read_b64_tr_b16 v[246:247], v4 offset:29696
    s_waitcnt lgkmcnt(12)
    v_mfma_f32_32x32x16_bf16 v[192:207], v[220:223], v[100:103], v[192:207]
    ds_read_b64_tr_b16 v[248:249], v5 offset:28672
    ds_read_b64_tr_b16 v[250:251], v5 offset:29696
    s_waitcnt lgkmcnt(12)
    v_mfma_f32_32x32x16_bf16 v[144:159], v[224:227], v[104:107], v[144:159]
    ds_read_b64_tr_b16 v[252:253], v6 offset:28672
    ds_read_b64_tr_b16 v[254:255], v6 offset:29696
    s_waitcnt lgkmcnt(12)
    v_mfma_f32_32x32x16_bf16 v[160:175], v[228:231], v[104:107], v[160:175]
    s_waitcnt lgkmcnt(10)
    v_mfma_f32_32x32x16_bf16 v[176:191], v[232:235], v[104:107], v[176:191]
    s_waitcnt lgkmcnt(8)
    v_mfma_f32_32x32x16_bf16 v[192:207], v[236:239], v[104:107], v[192:207]
    s_waitcnt lgkmcnt(6)
    v_mfma_f32_32x32x16_bf16 v[144:159], v[240:243], v[108:111], v[144:159]
    s_waitcnt lgkmcnt(4)
    v_mfma_f32_32x32x16_bf16 v[160:175], v[244:247], v[108:111], v[160:175]
    s_waitcnt lgkmcnt(2)
    v_mfma_f32_32x32x16_bf16 v[176:191], v[248:251], v[108:111], v[176:191]
    s_waitcnt lgkmcnt(0)
    v_mfma_f32_32x32x16_bf16 v[192:207], v[252:255], v[108:111], v[192:207]
    s_barrier
    buffer_load_dwordx4 v[96:99], v14, s[12:15], s48 offen offset:0 nt
    buffer_load_dwordx4 v[100:103], v14, s[12:15], s48 offen offset:1024 nt
    buffer_load_dwordx4 v[104:107], v14, s[12:15], s48 offen offset:2048 nt
    buffer_load_dwordx4 v[108:111], v14, s[12:15], s48 offen offset:3072 nt
    s_add_u32 s48, s48, 4096
    s_waitcnt vmcnt(28)
    ds_read_b64_tr_b16 v[208:209], v3 offset:32768
    ds_read_b64_tr_b16 v[210:211], v3 offset:33792
    ds_read_b64_tr_b16 v[212:213], v4 offset:32768
    ds_read_b64_tr_b16 v[214:215], v4 offset:33792
    ds_read_b64_tr_b16 v[216:217], v5 offset:32768
    ds_read_b64_tr_b16 v[218:219], v5 offset:33792
    ds_read_b64_tr_b16 v[220:221], v6 offset:32768
    ds_read_b64_tr_b16 v[222:223], v6 offset:33792
    ds_read_b64_tr_b16 v[224:225], v3 offset:36864
    ds_read_b64_tr_b16 v[226:227], v3 offset:37888
    ds_read_b64_tr_b16 v[228:229], v4 offset:36864
    ds_read_b64_tr_b16 v[230:231], v4 offset:37888
    ds_read_b64_tr_b16 v[232:233], v5 offset:36864
    ds_read_b64_tr_b16 v[234:235], v5 offset:37888
    s_waitcnt lgkmcnt(12)
    v_mfma_f32_32x32x16_bf16 v[144:159], v[208:211], v[112:115], v[144:159]
    ds_read_b64_tr_b16 v[236:237], v6 offset:36864
    ds_read_b64_tr_b16 v[238:239], v6 offset:37888
    s_waitcnt lgkmcnt(12)
    v_mfma_f32_32x32x16_bf16 v[160:175], v[212:215], v[112:115], v[160:175]
    ds_read_b64_tr_b16 v[240:241], v3 offset:40960
    ds_read_b64_tr_b16 v[242:243], v3 offset:41984
    s_waitcnt lgkmcnt(12)
    v_mfma_f32_32x32x16_bf16 v[176:191], v[216:219], v[112:115], v[176:191]
    ds_read_b64_tr_b16 v[244:245], v4 offset:40960
    ds_read_b64_tr_b16 v[246:247], v4 offset:41984
    s_waitcnt lgkmcnt(12)
    v_mfma_f32_32x32x16_bf16 v[192:207], v[220:223], v[112:115], v[192:207]
    ds_read_b64_tr_b16 v[248:249], v5 offset:40960
    ds_read_b64_tr_b16 v[250:251], v5 offset:41984
    s_waitcnt lgkmcnt(12)
    v_mfma_f32_32x32x16_bf16 v[144:159], v[224:227], v[116:119], v[144:159]
    ds_read_b64_tr_b16 v[252:253], v6 offset:40960
    ds_read_b64_tr_b16 v[254:255], v6 offset:41984
    s_waitcnt lgkmcnt(12)
    v_mfma_f32_32x32x16_bf16 v[160:175], v[228:231], v[116:119], v[160:175]
    ds_read_b64_tr_b16 v[208:209], v3 offset:45056
    ds_read_b64_tr_b16 v[210:211], v3 offset:46080
    s_waitcnt lgkmcnt(12)
    v_mfma_f32_32x32x16_bf16 v[176:191], v[232:235], v[116:119], v[176:191]
    ds_read_b64_tr_b16 v[212:213], v4 offset:45056
    ds_read_b64_tr_b16 v[214:215], v4 offset:46080
    s_waitcnt lgkmcnt(12)
    v_mfma_f32_32x32x16_bf16 v[192:207], v[236:239], v[116:119], v[192:207]
    ds_read_b64_tr_b16 v[216:217], v5 offset:45056
    ds_read_b64_tr_b16 v[218:219], v5 offset:46080
    s_waitcnt lgkmcnt(12)
    v_mfma_f32_32x32x16_bf16 v[144:159], v[240:243], v[120:123], v[144:159]
    ds_read_b64_tr_b16 v[220:221], v6 offset:45056
    ds_read_b64_tr_b16 v[222:223], v6 offset:46080
    s_waitcnt lgkmcnt(12)
    v_mfma_f32_32x32x16_bf16 v[160:175], v[244:247], v[120:123], v[160:175]
    s_waitcnt lgkmcnt(10)
    v_mfma_f32_32x32x16_bf16 v[176:191], v[248:251], v[120:123], v[176:191]
    s_waitcnt lgkmcnt(8)
    v_mfma_f32_32x32x16_bf16 v[192:207], v[252:255], v[120:123], v[192:207]
    s_waitcnt lgkmcnt(6)
    v_mfma_f32_32x32x16_bf16 v[144:159], v[208:211], v[124:127], v[144:159]
    s_waitcnt lgkmcnt(4)
    v_mfma_f32_32x32x16_bf16 v[160:175], v[212:215], v[124:127], v[160:175]
    s_waitcnt lgkmcnt(2)
    v_mfma_f32_32x32x16_bf16 v[176:191], v[216:219], v[124:127], v[176:191]
    s_waitcnt lgkmcnt(0)
    v_mfma_f32_32x32x16_bf16 v[192:207], v[220:223], v[124:127], v[192:207]
    buffer_load_dwordx4 v[112:115], v14, s[12:15], s48 offen offset:0 nt
    buffer_load_dwordx4 v[116:119], v14, s[12:15], s48 offen offset:1024 nt
    buffer_load_dwordx4 v[120:123], v14, s[12:15], s48 offen offset:2048 nt
    buffer_load_dwordx4 v[124:127], v14, s[12:15], s48 offen offset:3072 nt
    s_add_u32 s48, s48, 4096
    s_waitcnt vmcnt(28)
    ds_read_b64_tr_b16 v[224:225], v3 offset:49152
    ds_read_b64_tr_b16 v[226:227], v3 offset:50176
    ds_read_b64_tr_b16 v[228:229], v4 offset:49152
    ds_read_b64_tr_b16 v[230:231], v4 offset:50176
    ds_read_b64_tr_b16 v[232:233], v5 offset:49152
    ds_read_b64_tr_b16 v[234:235], v5 offset:50176
    ds_read_b64_tr_b16 v[236:237], v6 offset:49152
    ds_read_b64_tr_b16 v[238:239], v6 offset:50176
    ds_read_b64_tr_b16 v[240:241], v3 offset:53248
    ds_read_b64_tr_b16 v[242:243], v3 offset:54272
    ds_read_b64_tr_b16 v[244:245], v4 offset:53248
    ds_read_b64_tr_b16 v[246:247], v4 offset:54272
    ds_read_b64_tr_b16 v[248:249], v5 offset:53248
    ds_read_b64_tr_b16 v[250:251], v5 offset:54272
    s_waitcnt lgkmcnt(12)
    v_mfma_f32_32x32x16_bf16 v[144:159], v[224:227], v[128:131], v[144:159]
    ds_read_b64_tr_b16 v[252:253], v6 offset:53248
    ds_read_b64_tr_b16 v[254:255], v6 offset:54272
    s_waitcnt lgkmcnt(12)
    v_mfma_f32_32x32x16_bf16 v[160:175], v[228:231], v[128:131], v[160:175]
    ds_read_b64_tr_b16 v[208:209], v3 offset:57344
    ds_read_b64_tr_b16 v[210:211], v3 offset:58368
    s_waitcnt lgkmcnt(12)
    v_mfma_f32_32x32x16_bf16 v[176:191], v[232:235], v[128:131], v[176:191]
    ds_read_b64_tr_b16 v[212:213], v4 offset:57344
    ds_read_b64_tr_b16 v[214:215], v4 offset:58368
    s_waitcnt lgkmcnt(12)
    v_mfma_f32_32x32x16_bf16 v[192:207], v[236:239], v[128:131], v[192:207]
    ds_read_b64_tr_b16 v[216:217], v5 offset:57344
    ds_read_b64_tr_b16 v[218:219], v5 offset:58368
    s_waitcnt lgkmcnt(12)
    v_mfma_f32_32x32x16_bf16 v[144:159], v[240:243], v[132:135], v[144:159]
    ds_read_b64_tr_b16 v[220:221], v6 offset:57344
    ds_read_b64_tr_b16 v[222:223], v6 offset:58368
    s_waitcnt lgkmcnt(12)
    v_mfma_f32_32x32x16_bf16 v[160:175], v[244:247], v[132:135], v[160:175]
    ds_read_b64_tr_b16 v[224:225], v3 offset:61440
    ds_read_b64_tr_b16 v[226:227], v3 offset:62464
    s_waitcnt lgkmcnt(12)
    v_mfma_f32_32x32x16_bf16 v[176:191], v[248:251], v[132:135], v[176:191]
    ds_read_b64_tr_b16 v[228:229], v4 offset:61440
    ds_read_b64_tr_b16 v[230:231], v4 offset:62464
    s_waitcnt lgkmcnt(12)
    v_mfma_f32_32x32x16_bf16 v[192:207], v[252:255], v[132:135], v[192:207]
    ds_read_b64_tr_b16 v[232:233], v5 offset:61440
    ds_read_b64_tr_b16 v[234:235], v5 offset:62464
    s_waitcnt lgkmcnt(12)
    v_mfma_f32_32x32x16_bf16 v[144:159], v[208:211], v[136:139], v[144:159]
    ds_read_b64_tr_b16 v[236:237], v6 offset:61440
    ds_read_b64_tr_b16 v[238:239], v6 offset:62464
    s_waitcnt lgkmcnt(12)
    v_mfma_f32_32x32x16_bf16 v[160:175], v[212:215], v[136:139], v[160:175]
    s_waitcnt lgkmcnt(10)
    v_mfma_f32_32x32x16_bf16 v[176:191], v[216:219], v[136:139], v[176:191]
    s_waitcnt lgkmcnt(8)
    v_mfma_f32_32x32x16_bf16 v[192:207], v[220:223], v[136:139], v[192:207]
    s_waitcnt lgkmcnt(6)
    v_mfma_f32_32x32x16_bf16 v[144:159], v[224:227], v[140:143], v[144:159]
    s_waitcnt lgkmcnt(4)
    v_mfma_f32_32x32x16_bf16 v[160:175], v[228:231], v[140:143], v[160:175]
    s_waitcnt lgkmcnt(2)
    v_mfma_f32_32x32x16_bf16 v[176:191], v[232:235], v[140:143], v[176:191]
    s_waitcnt lgkmcnt(0)
    v_mfma_f32_32x32x16_bf16 v[192:207], v[236:239], v[140:143], v[192:207]
    s_barrier
    buffer_load_dwordx4 v[128:131], v14, s[12:15], s48 offen offset:0 nt
    buffer_load_dwordx4 v[132:135], v14, s[12:15], s48 offen offset:1024 nt
    buffer_load_dwordx4 v[136:139], v14, s[12:15], s48 offen offset:2048 nt
    buffer_load_dwordx4 v[140:143], v14, s[12:15], s48 offen offset:3072 nt
    s_add_u32 s48, s48, 4096
    s_waitcnt vmcnt(28)
    ds_read_b64_tr_b16 v[240:241], v10 offset:0
    ds_read_b64_tr_b16 v[242:243], v10 offset:1024
    ds_read_b64_tr_b16 v[244:245], v11 offset:0
    ds_read_b64_tr_b16 v[246:247], v11 offset:1024
    ds_read_b64_tr_b16 v[248:249], v12 offset:0
    ds_read_b64_tr_b16 v[250:251], v12 offset:1024
    ds_read_b64_tr_b16 v[252:253], v13 offset:0
    ds_read_b64_tr_b16 v[254:255], v13 offset:1024
    ds_read_b64_tr_b16 v[208:209], v10 offset:4096
    ds_read_b64_tr_b16 v[210:211], v10 offset:5120
    ds_read_b64_tr_b16 v[212:213], v11 offset:4096
    ds_read_b64_tr_b16 v[214:215], v11 offset:5120
    ds_read_b64_tr_b16 v[216:217], v12 offset:4096
    ds_read_b64_tr_b16 v[218:219], v12 offset:5120
    s_waitcnt lgkmcnt(12)
    v_mfma_f32_32x32x16_bf16 v[144:159], v[240:243], v[16:19], v[144:159]
    ds_read_b64_tr_b16 v[220:221], v13 offset:4096
    ds_read_b64_tr_b16 v[222:223], v13 offset:5120
    s_waitcnt lgkmcnt(12)
    v_mfma_f32_32x32x16_bf16 v[160:175], v[244:247], v[16:19], v[160:175]
    ds_read_b64_tr_b16 v[224:225], v10 offset:8192
    ds_read_b64_tr_b16 v[226:227], v10 offset:9216
    s_waitcnt lgkmcnt(12)
    v_mfma_f32_32x32x16_bf16 v[176:191], v[248:251], v[16:19], v[176:191]
    ds_read_b64_tr_b16 v[228:229], v11 offset:8192
    ds_read_b64_tr_b16 v[230:231], v11 offset:9216
    s_waitcnt lgkmcnt(12)
    v_mfma_f32_32x32x16_bf16 v[192:207], v[252:255], v[16:19], v[192:207]
    ds_read_b64_tr_b16 v[232:233], v12 offset:8192
    ds_read_b64_tr_b16 v[234:235], v12 offset:9216
    s_waitcnt lgkmcnt(12)
    v_mfma_f32_32x32x16_bf16 v[144:159], v[208:211], v[20:23], v[144:159]
    ds_read_b64_tr_b16 v[236:237], v13 offset:8192
    ds_read_b64_tr_b16 v[238:239], v13 offset:9216
    s_waitcnt lgkmcnt(12)
    v_mfma_f32_32x32x16_bf16 v[160:175], v[212:215], v[20:23], v[160:175]
    ds_read_b64_tr_b16 v[240:241], v10 offset:12288
    ds_read_b64_tr_b16 v[242:243], v10 offset:13312
    s_waitcnt lgkmcnt(12)
    v_mfma_f32_32x32x16_bf16 v[176:191], v[216:219], v[20:23], v[176:191]
    ds_read_b64_tr_b16 v[244:245], v11 offset:12288
    ds_read_b64_tr_b16 v[246:247], v11 offset:13312
    s_waitcnt lgkmcnt(12)
    v_mfma_f32_32x32x16_bf16 v[192:207], v[220:223], v[20:23], v[192:207]
    ds_read_b64_tr_b16 v[248:249], v12 offset:12288
    ds_read_b64_tr_b16 v[250:251], v12 offset:13312
    s_waitcnt lgkmcnt(12)
    v_mfma_f32_32x32x16_bf16 v[144:159], v[224:227], v[24:27], v[144:159]
    ds_read_b64_tr_b16 v[252:253], v13 offset:12288
    ds_read_b64_tr_b16 v[254:255], v13 offset:13312
    s_waitcnt lgkmcnt(12)
    v_mfma_f32_32x32x16_bf16 v[160:175], v[228:231], v[24:27], v[160:175]
    s_waitcnt lgkmcnt(10)
    v_mfma_f32_32x32x16_bf16 v[176:191], v[232:235], v[24:27], v[176:191]
    s_waitcnt lgkmcnt(8)
    v_mfma_f32_32x32x16_bf16 v[192:207], v[236:239], v[24:27], v[192:207]
    s_waitcnt lgkmcnt(6)
    v_mfma_f32_32x32x16_bf16 v[144:159], v[240:243], v[28:31], v[144:159]
    s_waitcnt lgkmcnt(4)
    v_mfma_f32_32x32x16_bf16 v[160:175], v[244:247], v[28:31], v[160:175]
    s_waitcnt lgkmcnt(2)
    v_mfma_f32_32x32x16_bf16 v[176:191], v[248:251], v[28:31], v[176:191]
    s_waitcnt lgkmcnt(0)
    v_mfma_f32_32x32x16_bf16 v[192:207], v[252:255], v[28:31], v[192:207]
    buffer_load_dwordx4 v[16:19], v14, s[12:15], s48 offen offset:0 nt
    buffer_load_dwordx4 v[20:23], v14, s[12:15], s48 offen offset:1024 nt
    buffer_load_dwordx4 v[24:27], v14, s[12:15], s48 offen offset:2048 nt
    buffer_load_dwordx4 v[28:31], v14, s[12:15], s48 offen offset:3072 nt
    s_add_u32 s48, s48, 4096
    s_waitcnt vmcnt(28)
    ds_read_b64_tr_b16 v[208:209], v10 offset:16384
    ds_read_b64_tr_b16 v[210:211], v10 offset:17408
    ds_read_b64_tr_b16 v[212:213], v11 offset:16384
    ds_read_b64_tr_b16 v[214:215], v11 offset:17408
    ds_read_b64_tr_b16 v[216:217], v12 offset:16384
    ds_read_b64_tr_b16 v[218:219], v12 offset:17408
    ds_read_b64_tr_b16 v[220:221], v13 offset:16384
    ds_read_b64_tr_b16 v[222:223], v13 offset:17408
    ds_read_b64_tr_b16 v[224:225], v10 offset:20480
    ds_read_b64_tr_b16 v[226:227], v10 offset:21504
    ds_read_b64_tr_b16 v[228:229], v11 offset:20480
    ds_read_b64_tr_b16 v[230:231], v11 offset:21504
    ds_read_b64_tr_b16 v[232:233], v12 offset:20480
    ds_read_b64_tr_b16 v[234:235], v12 offset:21504
    s_waitcnt lgkmcnt(12)
    v_mfma_f32_32x32x16_bf16 v[144:159], v[208:211], v[32:35], v[144:159]
    ds_read_b64_tr_b16 v[236:237], v13 offset:20480
    ds_read_b64_tr_b16 v[238:239], v13 offset:21504
    s_waitcnt lgkmcnt(12)
    v_mfma_f32_32x32x16_bf16 v[160:175], v[212:215], v[32:35], v[160:175]
    ds_read_b64_tr_b16 v[240:241], v10 offset:24576
    ds_read_b64_tr_b16 v[242:243], v10 offset:25600
    s_waitcnt lgkmcnt(12)
    v_mfma_f32_32x32x16_bf16 v[176:191], v[216:219], v[32:35], v[176:191]
    ds_read_b64_tr_b16 v[244:245], v11 offset:24576
    ds_read_b64_tr_b16 v[246:247], v11 offset:25600
    s_waitcnt lgkmcnt(12)
    v_mfma_f32_32x32x16_bf16 v[192:207], v[220:223], v[32:35], v[192:207]
    ds_read_b64_tr_b16 v[248:249], v12 offset:24576
    ds_read_b64_tr_b16 v[250:251], v12 offset:25600
    s_waitcnt lgkmcnt(12)
    v_mfma_f32_32x32x16_bf16 v[144:159], v[224:227], v[36:39], v[144:159]
    ds_read_b64_tr_b16 v[252:253], v13 offset:24576
    ds_read_b64_tr_b16 v[254:255], v13 offset:25600
    s_waitcnt lgkmcnt(12)
    v_mfma_f32_32x32x16_bf16 v[160:175], v[228:231], v[36:39], v[160:175]
    ds_read_b64_tr_b16 v[208:209], v10 offset:28672
    ds_read_b64_tr_b16 v[210:211], v10 offset:29696
    s_waitcnt lgkmcnt(12)
    v_mfma_f32_32x32x16_bf16 v[176:191], v[232:235], v[36:39], v[176:191]
    ds_read_b64_tr_b16 v[212:213], v11 offset:28672
    ds_read_b64_tr_b16 v[214:215], v11 offset:29696
    s_waitcnt lgkmcnt(12)
    v_mfma_f32_32x32x16_bf16 v[192:207], v[236:239], v[36:39], v[192:207]
    ds_read_b64_tr_b16 v[216:217], v12 offset:28672
    ds_read_b64_tr_b16 v[218:219], v12 offset:29696
    s_waitcnt lgkmcnt(12)
    v_mfma_f32_32x32x16_bf16 v[144:159], v[240:243], v[40:43], v[144:159]
    ds_read_b64_tr_b16 v[220:221], v13 offset:28672
    ds_read_b64_tr_b16 v[222:223], v13 offset:29696
    s_waitcnt lgkmcnt(12)
    v_mfma_f32_32x32x16_bf16 v[160:175], v[244:247], v[40:43], v[160:175]
    s_waitcnt lgkmcnt(10)
    v_mfma_f32_32x32x16_bf16 v[176:191], v[248:251], v[40:43], v[176:191]
    s_waitcnt lgkmcnt(8)
    v_mfma_f32_32x32x16_bf16 v[192:207], v[252:255], v[40:43], v[192:207]
    s_waitcnt lgkmcnt(6)
    v_mfma_f32_32x32x16_bf16 v[144:159], v[208:211], v[44:47], v[144:159]
    s_waitcnt lgkmcnt(4)
    v_mfma_f32_32x32x16_bf16 v[160:175], v[212:215], v[44:47], v[160:175]
    s_waitcnt lgkmcnt(2)
    v_mfma_f32_32x32x16_bf16 v[176:191], v[216:219], v[44:47], v[176:191]
    s_waitcnt lgkmcnt(0)
    v_mfma_f32_32x32x16_bf16 v[192:207], v[220:223], v[44:47], v[192:207]
    s_barrier
    buffer_load_dwordx4 v[32:35], v14, s[12:15], s48 offen offset:0 nt
    buffer_load_dwordx4 v[36:39], v14, s[12:15], s48 offen offset:1024 nt
    buffer_load_dwordx4 v[40:43], v14, s[12:15], s48 offen offset:2048 nt
    buffer_load_dwordx4 v[44:47], v14, s[12:15], s48 offen offset:3072 nt
    s_add_u32 s48, s48, 4096
    s_waitcnt vmcnt(28)
    ds_read_b64_tr_b16 v[224:225], v10 offset:32768
    ds_read_b64_tr_b16 v[226:227], v10 offset:33792
    ds_read_b64_tr_b16 v[228:229], v11 offset:32768
    ds_read_b64_tr_b16 v[230:231], v11 offset:33792
    ds_read_b64_tr_b16 v[232:233], v12 offset:32768
    ds_read_b64_tr_b16 v[234:235], v12 offset:33792
    ds_read_b64_tr_b16 v[236:237], v13 offset:32768
    ds_read_b64_tr_b16 v[238:239], v13 offset:33792
    ds_read_b64_tr_b16 v[240:241], v10 offset:36864
    ds_read_b64_tr_b16 v[242:243], v10 offset:37888
    ds_read_b64_tr_b16 v[244:245], v11 offset:36864
    ds_read_b64_tr_b16 v[246:247], v11 offset:37888
    ds_read_b64_tr_b16 v[248:249], v12 offset:36864
    ds_read_b64_tr_b16 v[250:251], v12 offset:37888
    s_waitcnt lgkmcnt(12)
    v_mfma_f32_32x32x16_bf16 v[144:159], v[224:227], v[48:51], v[144:159]
    ds_read_b64_tr_b16 v[252:253], v13 offset:36864
    ds_read_b64_tr_b16 v[254:255], v13 offset:37888
    s_waitcnt lgkmcnt(12)
    v_mfma_f32_32x32x16_bf16 v[160:175], v[228:231], v[48:51], v[160:175]
    ds_read_b64_tr_b16 v[208:209], v10 offset:40960
    ds_read_b64_tr_b16 v[210:211], v10 offset:41984
    s_waitcnt lgkmcnt(12)
    v_mfma_f32_32x32x16_bf16 v[176:191], v[232:235], v[48:51], v[176:191]
    ds_read_b64_tr_b16 v[212:213], v11 offset:40960
    ds_read_b64_tr_b16 v[214:215], v11 offset:41984
    s_waitcnt lgkmcnt(12)
    v_mfma_f32_32x32x16_bf16 v[192:207], v[236:239], v[48:51], v[192:207]
    ds_read_b64_tr_b16 v[216:217], v12 offset:40960
    ds_read_b64_tr_b16 v[218:219], v12 offset:41984
    s_waitcnt lgkmcnt(12)
    v_mfma_f32_32x32x16_bf16 v[144:159], v[240:243], v[52:55], v[144:159]
    ds_read_b64_tr_b16 v[220:221], v13 offset:40960
    ds_read_b64_tr_b16 v[222:223], v13 offset:41984
    s_waitcnt lgkmcnt(12)
    v_mfma_f32_32x32x16_bf16 v[160:175], v[244:247], v[52:55], v[160:175]
    ds_read_b64_tr_b16 v[224:225], v10 offset:45056
    ds_read_b64_tr_b16 v[226:227], v10 offset:46080
    s_waitcnt lgkmcnt(12)
    v_mfma_f32_32x32x16_bf16 v[176:191], v[248:251], v[52:55], v[176:191]
    ds_read_b64_tr_b16 v[228:229], v11 offset:45056
    ds_read_b64_tr_b16 v[230:231], v11 offset:46080
    s_waitcnt lgkmcnt(12)
    v_mfma_f32_32x32x16_bf16 v[192:207], v[252:255], v[52:55], v[192:207]
    ds_read_b64_tr_b16 v[232:233], v12 offset:45056
    ds_read_b64_tr_b16 v[234:235], v12 offset:46080
    s_waitcnt lgkmcnt(12)
    v_mfma_f32_32x32x16_bf16 v[144:159], v[208:211], v[56:59], v[144:159]
    ds_read_b64_tr_b16 v[236:237], v13 offset:45056
    ds_read_b64_tr_b16 v[238:239], v13 offset:46080
    s_waitcnt lgkmcnt(12)
    v_mfma_f32_32x32x16_bf16 v[160:175], v[212:215], v[56:59], v[160:175]
    s_waitcnt lgkmcnt(10)
    v_mfma_f32_32x32x16_bf16 v[176:191], v[216:219], v[56:59], v[176:191]
    s_waitcnt lgkmcnt(8)
    v_mfma_f32_32x32x16_bf16 v[192:207], v[220:223], v[56:59], v[192:207]
    s_waitcnt lgkmcnt(6)
    v_mfma_f32_32x32x16_bf16 v[144:159], v[224:227], v[60:63], v[144:159]
    s_waitcnt lgkmcnt(4)
    v_mfma_f32_32x32x16_bf16 v[160:175], v[228:231], v[60:63], v[160:175]
    s_waitcnt lgkmcnt(2)
    v_mfma_f32_32x32x16_bf16 v[176:191], v[232:235], v[60:63], v[176:191]
    s_waitcnt lgkmcnt(0)
    v_mfma_f32_32x32x16_bf16 v[192:207], v[236:239], v[60:63], v[192:207]
    buffer_load_dwordx4 v[48:51], v14, s[12:15], s48 offen offset:0 nt
    buffer_load_dwordx4 v[52:55], v14, s[12:15], s48 offen offset:1024 nt
    buffer_load_dwordx4 v[56:59], v14, s[12:15], s48 offen offset:2048 nt
    buffer_load_dwordx4 v[60:63], v14, s[12:15], s48 offen offset:3072 nt
    s_add_u32 s48, s48, 4096
    s_waitcnt vmcnt(28)
    ds_read_b64_tr_b16 v[240:241], v10 offset:49152
    ds_read_b64_tr_b16 v[242:243], v10 offset:50176
    ds_read_b64_tr_b16 v[244:245], v11 offset:49152
    ds_read_b64_tr_b16 v[246:247], v11 offset:50176
    ds_read_b64_tr_b16 v[248:249], v12 offset:49152
    ds_read_b64_tr_b16 v[250:251], v12 offset:50176
    ds_read_b64_tr_b16 v[252:253], v13 offset:49152
    ds_read_b64_tr_b16 v[254:255], v13 offset:50176
    ds_read_b64_tr_b16 v[208:209], v10 offset:53248
    ds_read_b64_tr_b16 v[210:211], v10 offset:54272
    ds_read_b64_tr_b16 v[212:213], v11 offset:53248
    ds_read_b64_tr_b16 v[214:215], v11 offset:54272
    ds_read_b64_tr_b16 v[216:217], v12 offset:53248
    ds_read_b64_tr_b16 v[218:219], v12 offset:54272
    s_waitcnt lgkmcnt(12)
    v_mfma_f32_32x32x16_bf16 v[144:159], v[240:243], v[64:67], v[144:159]
    ds_read_b64_tr_b16 v[220:221], v13 offset:53248
    ds_read_b64_tr_b16 v[222:223], v13 offset:54272
    s_waitcnt lgkmcnt(12)
    v_mfma_f32_32x32x16_bf16 v[160:175], v[244:247], v[64:67], v[160:175]
    ds_read_b64_tr_b16 v[224:225], v10 offset:57344
    ds_read_b64_tr_b16 v[226:227], v10 offset:58368
    s_waitcnt lgkmcnt(12)
    v_mfma_f32_32x32x16_bf16 v[176:191], v[248:251], v[64:67], v[176:191]
    ds_read_b64_tr_b16 v[228:229], v11 offset:57344
    ds_read_b64_tr_b16 v[230:231], v11 offset:58368
    s_waitcnt lgkmcnt(12)
    v_mfma_f32_32x32x16_bf16 v[192:207], v[252:255], v[64:67], v[192:207]
    ds_read_b64_tr_b16 v[232:233], v12 offset:57344
    ds_read_b64_tr_b16 v[234:235], v12 offset:58368
    s_waitcnt lgkmcnt(12)
    v_mfma_f32_32x32x16_bf16 v[144:159], v[208:211], v[68:71], v[144:159]
    ds_read_b64_tr_b16 v[236:237], v13 offset:57344
    ds_read_b64_tr_b16 v[238:239], v13 offset:58368
    s_waitcnt lgkmcnt(12)
    v_mfma_f32_32x32x16_bf16 v[160:175], v[212:215], v[68:71], v[160:175]
    ds_read_b64_tr_b16 v[240:241], v10 offset:61440
    ds_read_b64_tr_b16 v[242:243], v10 offset:62464
    s_waitcnt lgkmcnt(12)
    v_mfma_f32_32x32x16_bf16 v[176:191], v[216:219], v[68:71], v[176:191]
    ds_read_b64_tr_b16 v[244:245], v11 offset:61440
    ds_read_b64_tr_b16 v[246:247], v11 offset:62464
    s_waitcnt lgkmcnt(12)
    v_mfma_f32_32x32x16_bf16 v[192:207], v[220:223], v[68:71], v[192:207]
    ds_read_b64_tr_b16 v[248:249], v12 offset:61440
    ds_read_b64_tr_b16 v[250:251], v12 offset:62464
    s_waitcnt lgkmcnt(12)
    v_mfma_f32_32x32x16_bf16 v[144:159], v[224:227], v[72:75], v[144:159]
    ds_read_b64_tr_b16 v[252:253], v13 offset:61440
    ds_read_b64_tr_b16 v[254:255], v13 offset:62464
    s_waitcnt lgkmcnt(12)
    v_mfma_f32_32x32x16_bf16 v[160:175], v[228:231], v[72:75], v[160:175]
    s_waitcnt lgkmcnt(10)
    v_mfma_f32_32x32x16_bf16 v[176:191], v[232:235], v[72:75], v[176:191]
    s_waitcnt lgkmcnt(8)
    v_mfma_f32_32x32x16_bf16 v[192:207], v[236:239], v[72:75], v[192:207]
    s_waitcnt lgkmcnt(6)
    v_mfma_f32_32x32x16_bf16 v[144:159], v[240:243], v[76:79], v[144:159]
    s_waitcnt lgkmcnt(4)
    v_mfma_f32_32x32x16_bf16 v[160:175], v[244:247], v[76:79], v[160:175]
    s_waitcnt lgkmcnt(2)
    v_mfma_f32_32x32x16_bf16 v[176:191], v[248:251], v[76:79], v[176:191]
    s_waitcnt lgkmcnt(0)
    v_mfma_f32_32x32x16_bf16 v[192:207], v[252:255], v[76:79], v[192:207]
    s_barrier
    buffer_load_dwordx4 v[64:67], v14, s[12:15], s48 offen offset:0 nt
    buffer_load_dwordx4 v[68:71], v14, s[12:15], s48 offen offset:1024 nt
    buffer_load_dwordx4 v[72:75], v14, s[12:15], s48 offen offset:2048 nt
    buffer_load_dwordx4 v[76:79], v14, s[12:15], s48 offen offset:3072 nt
    s_add_u32 s48, s48, 4096
    s_waitcnt vmcnt(28)
    ds_read_b64_tr_b16 v[208:209], v3 offset:0
    ds_read_b64_tr_b16 v[210:211], v3 offset:1024
    ds_read_b64_tr_b16 v[212:213], v4 offset:0
    ds_read_b64_tr_b16 v[214:215], v4 offset:1024
    ds_read_b64_tr_b16 v[216:217], v5 offset:0
    ds_read_b64_tr_b16 v[218:219], v5 offset:1024
    ds_read_b64_tr_b16 v[220:221], v6 offset:0
    ds_read_b64_tr_b16 v[222:223], v6 offset:1024
    ds_read_b64_tr_b16 v[224:225], v3 offset:4096
    ds_read_b64_tr_b16 v[226:227], v3 offset:5120
    ds_read_b64_tr_b16 v[228:229], v4 offset:4096
    ds_read_b64_tr_b16 v[230:231], v4 offset:5120
    ds_read_b64_tr_b16 v[232:233], v5 offset:4096
    ds_read_b64_tr_b16 v[234:235], v5 offset:5120
    s_waitcnt lgkmcnt(12)
    v_mfma_f32_32x32x16_bf16 v[144:159], v[208:211], v[80:83], v[144:159]
    ds_read_b64_tr_b16 v[236:237], v6 offset:4096
    ds_read_b64_tr_b16 v[238:239], v6 offset:5120
    s_waitcnt lgkmcnt(12)
    v_mfma_f32_32x32x16_bf16 v[160:175], v[212:215], v[80:83], v[160:175]
    ds_read_b64_tr_b16 v[240:241], v3 offset:8192
    ds_read_b64_tr_b16 v[242:243], v3 offset:9216
    s_waitcnt lgkmcnt(12)
    v_mfma_f32_32x32x16_bf16 v[176:191], v[216:219], v[80:83], v[176:191]
    ds_read_b64_tr_b16 v[244:245], v4 offset:8192
    ds_read_b64_tr_b16 v[246:247], v4 offset:9216
    s_waitcnt lgkmcnt(12)
    v_mfma_f32_32x32x16_bf16 v[192:207], v[220:223], v[80:83], v[192:207]
    ds_read_b64_tr_b16 v[248:249], v5 offset:8192
    ds_read_b64_tr_b16 v[250:251], v5 offset:9216
    s_waitcnt lgkmcnt(12)
    v_mfma_f32_32x32x16_bf16 v[144:159], v[224:227], v[84:87], v[144:159]
    ds_read_b64_tr_b16 v[252:253], v6 offset:8192
    ds_read_b64_tr_b16 v[254:255], v6 offset:9216
    s_waitcnt lgkmcnt(12)
    v_mfma_f32_32x32x16_bf16 v[160:175], v[228:231], v[84:87], v[160:175]
    ds_read_b64_tr_b16 v[208:209], v3 offset:12288
    ds_read_b64_tr_b16 v[210:211], v3 offset:13312
    s_waitcnt lgkmcnt(12)
    v_mfma_f32_32x32x16_bf16 v[176:191], v[232:235], v[84:87], v[176:191]
    ds_read_b64_tr_b16 v[212:213], v4 offset:12288
    ds_read_b64_tr_b16 v[214:215], v4 offset:13312
    s_waitcnt lgkmcnt(12)
    v_mfma_f32_32x32x16_bf16 v[192:207], v[236:239], v[84:87], v[192:207]
    ds_read_b64_tr_b16 v[216:217], v5 offset:12288
    ds_read_b64_tr_b16 v[218:219], v5 offset:13312
    s_waitcnt lgkmcnt(12)
    v_mfma_f32_32x32x16_bf16 v[144:159], v[240:243], v[88:91], v[144:159]
    ds_read_b64_tr_b16 v[220:221], v6 offset:12288
    ds_read_b64_tr_b16 v[222:223], v6 offset:13312
    s_waitcnt lgkmcnt(12)
    v_mfma_f32_32x32x16_bf16 v[160:175], v[244:247], v[88:91], v[160:175]
    s_waitcnt lgkmcnt(10)
    v_mfma_f32_32x32x16_bf16 v[176:191], v[248:251], v[88:91], v[176:191]
    s_waitcnt lgkmcnt(8)
    v_mfma_f32_32x32x16_bf16 v[192:207], v[252:255], v[88:91], v[192:207]
    s_waitcnt lgkmcnt(6)
    v_mfma_f32_32x32x16_bf16 v[144:159], v[208:211], v[92:95], v[144:159]
    s_waitcnt lgkmcnt(4)
    v_mfma_f32_32x32x16_bf16 v[160:175], v[212:215], v[92:95], v[160:175]
    s_waitcnt lgkmcnt(2)
    v_mfma_f32_32x32x16_bf16 v[176:191], v[216:219], v[92:95], v[176:191]
    s_waitcnt lgkmcnt(0)
    v_mfma_f32_32x32x16_bf16 v[192:207], v[220:223], v[92:95], v[192:207]
    buffer_load_dwordx4 v[80:83], v14, s[12:15], s48 offen offset:0 nt
    buffer_load_dwordx4 v[84:87], v14, s[12:15], s48 offen offset:1024 nt
    buffer_load_dwordx4 v[88:91], v14, s[12:15], s48 offen offset:2048 nt
    buffer_load_dwordx4 v[92:95], v14, s[12:15], s48 offen offset:3072 nt
    s_add_u32 s48, s48, 4096
    s_waitcnt vmcnt(28)
    ds_read_b64_tr_b16 v[224:225], v3 offset:16384
    ds_read_b64_tr_b16 v[226:227], v3 offset:17408
    ds_read_b64_tr_b16 v[228:229], v4 offset:16384
    ds_read_b64_tr_b16 v[230:231], v4 offset:17408
    ds_read_b64_tr_b16 v[232:233], v5 offset:16384
    ds_read_b64_tr_b16 v[234:235], v5 offset:17408
    ds_read_b64_tr_b16 v[236:237], v6 offset:16384
    ds_read_b64_tr_b16 v[238:239], v6 offset:17408
    ds_read_b64_tr_b16 v[240:241], v3 offset:20480
    ds_read_b64_tr_b16 v[242:243], v3 offset:21504
    ds_read_b64_tr_b16 v[244:245], v4 offset:20480
    ds_read_b64_tr_b16 v[246:247], v4 offset:21504
    ds_read_b64_tr_b16 v[248:249], v5 offset:20480
    ds_read_b64_tr_b16 v[250:251], v5 offset:21504
    s_waitcnt lgkmcnt(12)
    v_mfma_f32_32x32x16_bf16 v[144:159], v[224:227], v[96:99], v[144:159]
    ds_read_b64_tr_b16 v[252:253], v6 offset:20480
    ds_read_b64_tr_b16 v[254:255], v6 offset:21504
    s_waitcnt lgkmcnt(12)
    v_mfma_f32_32x32x16_bf16 v[160:175], v[228:231], v[96:99], v[160:175]
    ds_read_b64_tr_b16 v[208:209], v3 offset:24576
    ds_read_b64_tr_b16 v[210:211], v3 offset:25600
    s_waitcnt lgkmcnt(12)
    v_mfma_f32_32x32x16_bf16 v[176:191], v[232:235], v[96:99], v[176:191]
    ds_read_b64_tr_b16 v[212:213], v4 offset:24576
    ds_read_b64_tr_b16 v[214:215], v4 offset:25600
    s_waitcnt lgkmcnt(12)
    v_mfma_f32_32x32x16_bf16 v[192:207], v[236:239], v[96:99], v[192:207]
    ds_read_b64_tr_b16 v[216:217], v5 offset:24576
    ds_read_b64_tr_b16 v[218:219], v5 offset:25600
    s_waitcnt lgkmcnt(12)
    v_mfma_f32_32x32x16_bf16 v[144:159], v[240:243], v[100:103], v[144:159]
    ds_read_b64_tr_b16 v[220:221], v6 offset:24576
    ds_read_b64_tr_b16 v[222:223], v6 offset:25600
    s_waitcnt lgkmcnt(12)
    v_mfma_f32_32x32x16_bf16 v[160:175], v[244:247], v[100:103], v[160:175]
    ds_read_b64_tr_b16 v[224:225], v3 offset:28672
    ds_read_b64_tr_b16 v[226:227], v3 offset:29696
    s_waitcnt lgkmcnt(12)
    v_mfma_f32_32x32x16_bf16 v[176:191], v[248:251], v[100:103], v[176:191]
    ds_read_b64_tr_b16 v[228:229], v4 offset:28672
    ds_read_b64_tr_b16 v[230:231], v4 offset:29696
    s_waitcnt lgkmcnt(12)
    v_mfma_f32_32x32x16_bf16 v[192:207], v[252:255], v[100:103], v[192:207]
    ds_read_b64_tr_b16 v[232:233], v5 offset:28672
    ds_read_b64_tr_b16 v[234:235], v5 offset:29696
    s_waitcnt lgkmcnt(12)
    v_mfma_f32_32x32x16_bf16 v[144:159], v[208:211], v[104:107], v[144:159]
    ds_read_b64_tr_b16 v[236:237], v6 offset:28672
    ds_read_b64_tr_b16 v[238:239], v6 offset:29696
    s_waitcnt lgkmcnt(12)
    v_mfma_f32_32x32x16_bf16 v[160:175], v[212:215], v[104:107], v[160:175]
    s_waitcnt lgkmcnt(10)
    v_mfma_f32_32x32x16_bf16 v[176:191], v[216:219], v[104:107], v[176:191]
    s_waitcnt lgkmcnt(8)
    v_mfma_f32_32x32x16_bf16 v[192:207], v[220:223], v[104:107], v[192:207]
    s_waitcnt lgkmcnt(6)
    v_mfma_f32_32x32x16_bf16 v[144:159], v[224:227], v[108:111], v[144:159]
    s_waitcnt lgkmcnt(4)
    v_mfma_f32_32x32x16_bf16 v[160:175], v[228:231], v[108:111], v[160:175]
    s_waitcnt lgkmcnt(2)
    v_mfma_f32_32x32x16_bf16 v[176:191], v[232:235], v[108:111], v[176:191]
    s_waitcnt lgkmcnt(0)
    v_mfma_f32_32x32x16_bf16 v[192:207], v[236:239], v[108:111], v[192:207]
    s_barrier
    buffer_load_dwordx4 v[96:99], v14, s[12:15], s48 offen offset:0 nt
    buffer_load_dwordx4 v[100:103], v14, s[12:15], s48 offen offset:1024 nt
    buffer_load_dwordx4 v[104:107], v14, s[12:15], s48 offen offset:2048 nt
    buffer_load_dwordx4 v[108:111], v14, s[12:15], s48 offen offset:3072 nt
    s_add_u32 s48, s48, 4096
    s_waitcnt vmcnt(28)
    ds_read_b64_tr_b16 v[240:241], v3 offset:32768
    ds_read_b64_tr_b16 v[242:243], v3 offset:33792
    ds_read_b64_tr_b16 v[244:245], v4 offset:32768
    ds_read_b64_tr_b16 v[246:247], v4 offset:33792
    ds_read_b64_tr_b16 v[248:249], v5 offset:32768
    ds_read_b64_tr_b16 v[250:251], v5 offset:33792
    ds_read_b64_tr_b16 v[252:253], v6 offset:32768
    ds_read_b64_tr_b16 v[254:255], v6 offset:33792
    ds_read_b64_tr_b16 v[208:209], v3 offset:36864
    ds_read_b64_tr_b16 v[210:211], v3 offset:37888
    ds_read_b64_tr_b16 v[212:213], v4 offset:36864
    ds_read_b64_tr_b16 v[214:215], v4 offset:37888
    ds_read_b64_tr_b16 v[216:217], v5 offset:36864
    ds_read_b64_tr_b16 v[218:219], v5 offset:37888
    s_waitcnt lgkmcnt(12)
    v_mfma_f32_32x32x16_bf16 v[144:159], v[240:243], v[112:115], v[144:159]
    ds_read_b64_tr_b16 v[220:221], v6 offset:36864
    ds_read_b64_tr_b16 v[222:223], v6 offset:37888
    s_waitcnt lgkmcnt(12)
    v_mfma_f32_32x32x16_bf16 v[160:175], v[244:247], v[112:115], v[160:175]
    ds_read_b64_tr_b16 v[224:225], v3 offset:40960
    ds_read_b64_tr_b16 v[226:227], v3 offset:41984
    s_waitcnt lgkmcnt(12)
    v_mfma_f32_32x32x16_bf16 v[176:191], v[248:251], v[112:115], v[176:191]
    ds_read_b64_tr_b16 v[228:229], v4 offset:40960
    ds_read_b64_tr_b16 v[230:231], v4 offset:41984
    s_waitcnt lgkmcnt(12)
    v_mfma_f32_32x32x16_bf16 v[192:207], v[252:255], v[112:115], v[192:207]
    ds_read_b64_tr_b16 v[232:233], v5 offset:40960
    ds_read_b64_tr_b16 v[234:235], v5 offset:41984
    s_waitcnt lgkmcnt(12)
    v_mfma_f32_32x32x16_bf16 v[144:159], v[208:211], v[116:119], v[144:159]
    ds_read_b64_tr_b16 v[236:237], v6 offset:40960
    ds_read_b64_tr_b16 v[238:239], v6 offset:41984
    s_waitcnt lgkmcnt(12)
    v_mfma_f32_32x32x16_bf16 v[160:175], v[212:215], v[116:119], v[160:175]
    ds_read_b64_tr_b16 v[240:241], v3 offset:45056
    ds_read_b64_tr_b16 v[242:243], v3 offset:46080
    s_waitcnt lgkmcnt(12)
    v_mfma_f32_32x32x16_bf16 v[176:191], v[216:219], v[116:119], v[176:191]
    ds_read_b64_tr_b16 v[244:245], v4 offset:45056
    ds_read_b64_tr_b16 v[246:247], v4 offset:46080
    s_waitcnt lgkmcnt(12)
    v_mfma_f32_32x32x16_bf16 v[192:207], v[220:223], v[116:119], v[192:207]
    ds_read_b64_tr_b16 v[248:249], v5 offset:45056
    ds_read_b64_tr_b16 v[250:251], v5 offset:46080
    s_waitcnt lgkmcnt(12)
    v_mfma_f32_32x32x16_bf16 v[144:159], v[224:227], v[120:123], v[144:159]
    ds_read_b64_tr_b16 v[252:253], v6 offset:45056
    ds_read_b64_tr_b16 v[254:255], v6 offset:46080
    s_waitcnt lgkmcnt(12)
    v_mfma_f32_32x32x16_bf16 v[160:175], v[228:231], v[120:123], v[160:175]
    s_waitcnt lgkmcnt(10)
    v_mfma_f32_32x32x16_bf16 v[176:191], v[232:235], v[120:123], v[176:191]
    s_waitcnt lgkmcnt(8)
    v_mfma_f32_32x32x16_bf16 v[192:207], v[236:239], v[120:123], v[192:207]
    s_waitcnt lgkmcnt(6)
    v_mfma_f32_32x32x16_bf16 v[144:159], v[240:243], v[124:127], v[144:159]
    s_waitcnt lgkmcnt(4)
    v_mfma_f32_32x32x16_bf16 v[160:175], v[244:247], v[124:127], v[160:175]
    s_waitcnt lgkmcnt(2)
    v_mfma_f32_32x32x16_bf16 v[176:191], v[248:251], v[124:127], v[176:191]
    s_waitcnt lgkmcnt(0)
    v_mfma_f32_32x32x16_bf16 v[192:207], v[252:255], v[124:127], v[192:207]
    buffer_load_dwordx4 v[112:115], v14, s[12:15], s48 offen offset:0 nt
    buffer_load_dwordx4 v[116:119], v14, s[12:15], s48 offen offset:1024 nt
    buffer_load_dwordx4 v[120:123], v14, s[12:15], s48 offen offset:2048 nt
    buffer_load_dwordx4 v[124:127], v14, s[12:15], s48 offen offset:3072 nt
    s_add_u32 s48, s48, 4096
    s_waitcnt vmcnt(28)
    ds_read_b64_tr_b16 v[208:209], v3 offset:49152
    ds_read_b64_tr_b16 v[210:211], v3 offset:50176
    ds_read_b64_tr_b16 v[212:213], v4 offset:49152
    ds_read_b64_tr_b16 v[214:215], v4 offset:50176
    ds_read_b64_tr_b16 v[216:217], v5 offset:49152
    ds_read_b64_tr_b16 v[218:219], v5 offset:50176
    ds_read_b64_tr_b16 v[220:221], v6 offset:49152
    ds_read_b64_tr_b16 v[222:223], v6 offset:50176
    ds_read_b64_tr_b16 v[224:225], v3 offset:53248
    ds_read_b64_tr_b16 v[226:227], v3 offset:54272
    ds_read_b64_tr_b16 v[228:229], v4 offset:53248
    ds_read_b64_tr_b16 v[230:231], v4 offset:54272
    ds_read_b64_tr_b16 v[232:233], v5 offset:53248
    ds_read_b64_tr_b16 v[234:235], v5 offset:54272
    s_waitcnt lgkmcnt(12)
    v_mfma_f32_32x32x16_bf16 v[144:159], v[208:211], v[128:131], v[144:159]
    ds_read_b64_tr_b16 v[236:237], v6 offset:53248
    ds_read_b64_tr_b16 v[238:239], v6 offset:54272
    s_waitcnt lgkmcnt(12)
    v_mfma_f32_32x32x16_bf16 v[160:175], v[212:215], v[128:131], v[160:175]
    ds_read_b64_tr_b16 v[240:241], v3 offset:57344
    ds_read_b64_tr_b16 v[242:243], v3 offset:58368
    s_waitcnt lgkmcnt(12)
    v_mfma_f32_32x32x16_bf16 v[176:191], v[216:219], v[128:131], v[176:191]
    ds_read_b64_tr_b16 v[244:245], v4 offset:57344
    ds_read_b64_tr_b16 v[246:247], v4 offset:58368
    s_waitcnt lgkmcnt(12)
    v_mfma_f32_32x32x16_bf16 v[192:207], v[220:223], v[128:131], v[192:207]
    ds_read_b64_tr_b16 v[248:249], v5 offset:57344
    ds_read_b64_tr_b16 v[250:251], v5 offset:58368
    s_waitcnt lgkmcnt(12)
    v_mfma_f32_32x32x16_bf16 v[144:159], v[224:227], v[132:135], v[144:159]
    ds_read_b64_tr_b16 v[252:253], v6 offset:57344
    ds_read_b64_tr_b16 v[254:255], v6 offset:58368
    s_waitcnt lgkmcnt(12)
    v_mfma_f32_32x32x16_bf16 v[160:175], v[228:231], v[132:135], v[160:175]
    ds_read_b64_tr_b16 v[208:209], v3 offset:61440
    ds_read_b64_tr_b16 v[210:211], v3 offset:62464
    s_waitcnt lgkmcnt(12)
    v_mfma_f32_32x32x16_bf16 v[176:191], v[232:235], v[132:135], v[176:191]
    ds_read_b64_tr_b16 v[212:213], v4 offset:61440
    ds_read_b64_tr_b16 v[214:215], v4 offset:62464
    s_waitcnt lgkmcnt(12)
    v_mfma_f32_32x32x16_bf16 v[192:207], v[236:239], v[132:135], v[192:207]
    ds_read_b64_tr_b16 v[216:217], v5 offset:61440
    ds_read_b64_tr_b16 v[218:219], v5 offset:62464
    s_waitcnt lgkmcnt(12)
    v_mfma_f32_32x32x16_bf16 v[144:159], v[240:243], v[136:139], v[144:159]
    ds_read_b64_tr_b16 v[220:221], v6 offset:61440
    ds_read_b64_tr_b16 v[222:223], v6 offset:62464
    s_waitcnt lgkmcnt(12)
    v_mfma_f32_32x32x16_bf16 v[160:175], v[244:247], v[136:139], v[160:175]
    s_waitcnt lgkmcnt(10)
    v_mfma_f32_32x32x16_bf16 v[176:191], v[248:251], v[136:139], v[176:191]
    s_waitcnt lgkmcnt(8)
    v_mfma_f32_32x32x16_bf16 v[192:207], v[252:255], v[136:139], v[192:207]
    s_waitcnt lgkmcnt(6)
    v_mfma_f32_32x32x16_bf16 v[144:159], v[208:211], v[140:143], v[144:159]
    s_waitcnt lgkmcnt(4)
    v_mfma_f32_32x32x16_bf16 v[160:175], v[212:215], v[140:143], v[160:175]
    s_waitcnt lgkmcnt(2)
    v_mfma_f32_32x32x16_bf16 v[176:191], v[216:219], v[140:143], v[176:191]
    s_waitcnt lgkmcnt(0)
    v_mfma_f32_32x32x16_bf16 v[192:207], v[220:223], v[140:143], v[192:207]
    s_barrier
    buffer_load_dwordx4 v[128:131], v14, s[12:15], s48 offen offset:0 nt
    buffer_load_dwordx4 v[132:135], v14, s[12:15], s48 offen offset:1024 nt
    buffer_load_dwordx4 v[136:139], v14, s[12:15], s48 offen offset:2048 nt
    buffer_load_dwordx4 v[140:143], v14, s[12:15], s48 offen offset:3072 nt
    s_add_u32 s48, s48, 4096
    s_waitcnt vmcnt(28)
    ds_read_b64_tr_b16 v[224:225], v10 offset:0
    ds_read_b64_tr_b16 v[226:227], v10 offset:1024
    ds_read_b64_tr_b16 v[228:229], v11 offset:0
    ds_read_b64_tr_b16 v[230:231], v11 offset:1024
    ds_read_b64_tr_b16 v[232:233], v12 offset:0
    ds_read_b64_tr_b16 v[234:235], v12 offset:1024
    ds_read_b64_tr_b16 v[236:237], v13 offset:0
    ds_read_b64_tr_b16 v[238:239], v13 offset:1024
    ds_read_b64_tr_b16 v[240:241], v10 offset:4096
    ds_read_b64_tr_b16 v[242:243], v10 offset:5120
    ds_read_b64_tr_b16 v[244:245], v11 offset:4096
    ds_read_b64_tr_b16 v[246:247], v11 offset:5120
    ds_read_b64_tr_b16 v[248:249], v12 offset:4096
    ds_read_b64_tr_b16 v[250:251], v12 offset:5120
    s_waitcnt lgkmcnt(12)
    v_mfma_f32_32x32x16_bf16 v[144:159], v[224:227], v[16:19], v[144:159]
    ds_read_b64_tr_b16 v[252:253], v13 offset:4096
    ds_read_b64_tr_b16 v[254:255], v13 offset:5120
    s_waitcnt lgkmcnt(12)
    v_mfma_f32_32x32x16_bf16 v[160:175], v[228:231], v[16:19], v[160:175]
    ds_read_b64_tr_b16 v[208:209], v10 offset:8192
    ds_read_b64_tr_b16 v[210:211], v10 offset:9216
    s_waitcnt lgkmcnt(12)
    v_mfma_f32_32x32x16_bf16 v[176:191], v[232:235], v[16:19], v[176:191]
    ds_read_b64_tr_b16 v[212:213], v11 offset:8192
    ds_read_b64_tr_b16 v[214:215], v11 offset:9216
    s_waitcnt lgkmcnt(12)
    v_mfma_f32_32x32x16_bf16 v[192:207], v[236:239], v[16:19], v[192:207]
    ds_read_b64_tr_b16 v[216:217], v12 offset:8192
    ds_read_b64_tr_b16 v[218:219], v12 offset:9216
    s_waitcnt lgkmcnt(12)
    v_mfma_f32_32x32x16_bf16 v[144:159], v[240:243], v[20:23], v[144:159]
    ds_read_b64_tr_b16 v[220:221], v13 offset:8192
    ds_read_b64_tr_b16 v[222:223], v13 offset:9216
    s_waitcnt lgkmcnt(12)
    v_mfma_f32_32x32x16_bf16 v[160:175], v[244:247], v[20:23], v[160:175]
    ds_read_b64_tr_b16 v[224:225], v10 offset:12288
    ds_read_b64_tr_b16 v[226:227], v10 offset:13312
    s_waitcnt lgkmcnt(12)
    v_mfma_f32_32x32x16_bf16 v[176:191], v[248:251], v[20:23], v[176:191]
    ds_read_b64_tr_b16 v[228:229], v11 offset:12288
    ds_read_b64_tr_b16 v[230:231], v11 offset:13312
    s_waitcnt lgkmcnt(12)
    v_mfma_f32_32x32x16_bf16 v[192:207], v[252:255], v[20:23], v[192:207]
    ds_read_b64_tr_b16 v[232:233], v12 offset:12288
    ds_read_b64_tr_b16 v[234:235], v12 offset:13312
    s_waitcnt lgkmcnt(12)
    v_mfma_f32_32x32x16_bf16 v[144:159], v[208:211], v[24:27], v[144:159]
    ds_read_b64_tr_b16 v[236:237], v13 offset:12288
    ds_read_b64_tr_b16 v[238:239], v13 offset:13312
    s_waitcnt lgkmcnt(12)
    v_mfma_f32_32x32x16_bf16 v[160:175], v[212:215], v[24:27], v[160:175]
    s_waitcnt lgkmcnt(10)
    v_mfma_f32_32x32x16_bf16 v[176:191], v[216:219], v[24:27], v[176:191]
    s_waitcnt lgkmcnt(8)
    v_mfma_f32_32x32x16_bf16 v[192:207], v[220:223], v[24:27], v[192:207]
    s_waitcnt lgkmcnt(6)
    v_mfma_f32_32x32x16_bf16 v[144:159], v[224:227], v[28:31], v[144:159]
    s_waitcnt lgkmcnt(4)
    v_mfma_f32_32x32x16_bf16 v[160:175], v[228:231], v[28:31], v[160:175]
    s_waitcnt lgkmcnt(2)
    v_mfma_f32_32x32x16_bf16 v[176:191], v[232:235], v[28:31], v[176:191]
    s_waitcnt lgkmcnt(0)
    v_mfma_f32_32x32x16_bf16 v[192:207], v[236:239], v[28:31], v[192:207]
    s_waitcnt vmcnt(24)
    ds_read_b64_tr_b16 v[240:241], v10 offset:16384
    ds_read_b64_tr_b16 v[242:243], v10 offset:17408
    ds_read_b64_tr_b16 v[244:245], v11 offset:16384
    ds_read_b64_tr_b16 v[246:247], v11 offset:17408
    ds_read_b64_tr_b16 v[248:249], v12 offset:16384
    ds_read_b64_tr_b16 v[250:251], v12 offset:17408
    ds_read_b64_tr_b16 v[252:253], v13 offset:16384
    ds_read_b64_tr_b16 v[254:255], v13 offset:17408
    ds_read_b64_tr_b16 v[208:209], v10 offset:20480
    ds_read_b64_tr_b16 v[210:211], v10 offset:21504
    ds_read_b64_tr_b16 v[212:213], v11 offset:20480
    ds_read_b64_tr_b16 v[214:215], v11 offset:21504
    ds_read_b64_tr_b16 v[216:217], v12 offset:20480
    ds_read_b64_tr_b16 v[218:219], v12 offset:21504
    s_waitcnt lgkmcnt(12)
    v_mfma_f32_32x32x16_bf16 v[144:159], v[240:243], v[32:35], v[144:159]
    ds_read_b64_tr_b16 v[220:221], v13 offset:20480
    ds_read_b64_tr_b16 v[222:223], v13 offset:21504
    s_waitcnt lgkmcnt(12)
    v_mfma_f32_32x32x16_bf16 v[160:175], v[244:247], v[32:35], v[160:175]
    ds_read_b64_tr_b16 v[224:225], v10 offset:24576
    ds_read_b64_tr_b16 v[226:227], v10 offset:25600
    s_waitcnt lgkmcnt(12)
    v_mfma_f32_32x32x16_bf16 v[176:191], v[248:251], v[32:35], v[176:191]
    ds_read_b64_tr_b16 v[228:229], v11 offset:24576
    ds_read_b64_tr_b16 v[230:231], v11 offset:25600
    s_waitcnt lgkmcnt(12)
    v_mfma_f32_32x32x16_bf16 v[192:207], v[252:255], v[32:35], v[192:207]
    ds_read_b64_tr_b16 v[232:233], v12 offset:24576
    ds_read_b64_tr_b16 v[234:235], v12 offset:25600
    s_waitcnt lgkmcnt(12)
    v_mfma_f32_32x32x16_bf16 v[144:159], v[208:211], v[36:39], v[144:159]
    ds_read_b64_tr_b16 v[236:237], v13 offset:24576
    ds_read_b64_tr_b16 v[238:239], v13 offset:25600
    s_waitcnt lgkmcnt(12)
    v_mfma_f32_32x32x16_bf16 v[160:175], v[212:215], v[36:39], v[160:175]
    ds_read_b64_tr_b16 v[240:241], v10 offset:28672
    ds_read_b64_tr_b16 v[242:243], v10 offset:29696
    s_waitcnt lgkmcnt(12)
    v_mfma_f32_32x32x16_bf16 v[176:191], v[216:219], v[36:39], v[176:191]
    ds_read_b64_tr_b16 v[244:245], v11 offset:28672
    ds_read_b64_tr_b16 v[246:247], v11 offset:29696
    s_waitcnt lgkmcnt(12)
    v_mfma_f32_32x32x16_bf16 v[192:207], v[220:223], v[36:39], v[192:207]
    ds_read_b64_tr_b16 v[248:249], v12 offset:28672
    ds_read_b64_tr_b16 v[250:251], v12 offset:29696
    s_waitcnt lgkmcnt(12)
    v_mfma_f32_32x32x16_bf16 v[144:159], v[224:227], v[40:43], v[144:159]
    ds_read_b64_tr_b16 v[252:253], v13 offset:28672
    ds_read_b64_tr_b16 v[254:255], v13 offset:29696
    s_waitcnt lgkmcnt(12)
    v_mfma_f32_32x32x16_bf16 v[160:175], v[228:231], v[40:43], v[160:175]
    s_waitcnt lgkmcnt(10)
    v_mfma_f32_32x32x16_bf16 v[176:191], v[232:235], v[40:43], v[176:191]
    s_waitcnt lgkmcnt(8)
    v_mfma_f32_32x32x16_bf16 v[192:207], v[236:239], v[40:43], v[192:207]
    s_waitcnt lgkmcnt(6)
    v_mfma_f32_32x32x16_bf16 v[144:159], v[240:243], v[44:47], v[144:159]
    s_waitcnt lgkmcnt(4)
    v_mfma_f32_32x32x16_bf16 v[160:175], v[244:247], v[44:47], v[160:175]
    s_waitcnt lgkmcnt(2)
    v_mfma_f32_32x32x16_bf16 v[176:191], v[248:251], v[44:47], v[176:191]
    s_waitcnt lgkmcnt(0)
    v_mfma_f32_32x32x16_bf16 v[192:207], v[252:255], v[44:47], v[192:207]
    s_barrier
    s_waitcnt vmcnt(20)
    ds_read_b64_tr_b16 v[208:209], v10 offset:32768
    ds_read_b64_tr_b16 v[210:211], v10 offset:33792
    ds_read_b64_tr_b16 v[212:213], v11 offset:32768
    ds_read_b64_tr_b16 v[214:215], v11 offset:33792
    ds_read_b64_tr_b16 v[216:217], v12 offset:32768
    ds_read_b64_tr_b16 v[218:219], v12 offset:33792
    ds_read_b64_tr_b16 v[220:221], v13 offset:32768
    ds_read_b64_tr_b16 v[222:223], v13 offset:33792
    ds_read_b64_tr_b16 v[224:225], v10 offset:36864
    ds_read_b64_tr_b16 v[226:227], v10 offset:37888
    ds_read_b64_tr_b16 v[228:229], v11 offset:36864
    ds_read_b64_tr_b16 v[230:231], v11 offset:37888
    ds_read_b64_tr_b16 v[232:233], v12 offset:36864
    ds_read_b64_tr_b16 v[234:235], v12 offset:37888
    s_waitcnt lgkmcnt(12)
    v_mfma_f32_32x32x16_bf16 v[144:159], v[208:211], v[48:51], v[144:159]
    ds_read_b64_tr_b16 v[236:237], v13 offset:36864
    ds_read_b64_tr_b16 v[238:239], v13 offset:37888
    s_waitcnt lgkmcnt(12)
    v_mfma_f32_32x32x16_bf16 v[160:175], v[212:215], v[48:51], v[160:175]
    ds_read_b64_tr_b16 v[240:241], v10 offset:40960
    ds_read_b64_tr_b16 v[242:243], v10 offset:41984
    s_waitcnt lgkmcnt(12)
    v_mfma_f32_32x32x16_bf16 v[176:191], v[216:219], v[48:51], v[176:191]
    ds_read_b64_tr_b16 v[244:245], v11 offset:40960
    ds_read_b64_tr_b16 v[246:247], v11 offset:41984
    s_waitcnt lgkmcnt(12)
    v_mfma_f32_32x32x16_bf16 v[192:207], v[220:223], v[48:51], v[192:207]
    ds_read_b64_tr_b16 v[248:249], v12 offset:40960
    ds_read_b64_tr_b16 v[250:251], v12 offset:41984
    s_waitcnt lgkmcnt(12)
    v_mfma_f32_32x32x16_bf16 v[144:159], v[224:227], v[52:55], v[144:159]
    ds_read_b64_tr_b16 v[252:253], v13 offset:40960
    ds_read_b64_tr_b16 v[254:255], v13 offset:41984
    s_waitcnt lgkmcnt(12)
    v_mfma_f32_32x32x16_bf16 v[160:175], v[228:231], v[52:55], v[160:175]
    ds_read_b64_tr_b16 v[208:209], v10 offset:45056
    ds_read_b64_tr_b16 v[210:211], v10 offset:46080
    s_waitcnt lgkmcnt(12)
    v_mfma_f32_32x32x16_bf16 v[176:191], v[232:235], v[52:55], v[176:191]
    ds_read_b64_tr_b16 v[212:213], v11 offset:45056
    ds_read_b64_tr_b16 v[214:215], v11 offset:46080
    s_waitcnt lgkmcnt(12)
    v_mfma_f32_32x32x16_bf16 v[192:207], v[236:239], v[52:55], v[192:207]
    ds_read_b64_tr_b16 v[216:217], v12 offset:45056
    ds_read_b64_tr_b16 v[218:219], v12 offset:46080
    s_waitcnt lgkmcnt(12)
    v_mfma_f32_32x32x16_bf16 v[144:159], v[240:243], v[56:59], v[144:159]
    ds_read_b64_tr_b16 v[220:221], v13 offset:45056
    ds_read_b64_tr_b16 v[222:223], v13 offset:46080
    s_waitcnt lgkmcnt(12)
    v_mfma_f32_32x32x16_bf16 v[160:175], v[244:247], v[56:59], v[160:175]
    s_waitcnt lgkmcnt(10)
    v_mfma_f32_32x32x16_bf16 v[176:191], v[248:251], v[56:59], v[176:191]
    s_waitcnt lgkmcnt(8)
    v_mfma_f32_32x32x16_bf16 v[192:207], v[252:255], v[56:59], v[192:207]
    s_waitcnt lgkmcnt(6)
    v_mfma_f32_32x32x16_bf16 v[144:159], v[208:211], v[60:63], v[144:159]
    s_waitcnt lgkmcnt(4)
    v_mfma_f32_32x32x16_bf16 v[160:175], v[212:215], v[60:63], v[160:175]
    s_waitcnt lgkmcnt(2)
    v_mfma_f32_32x32x16_bf16 v[176:191], v[216:219], v[60:63], v[176:191]
    s_waitcnt lgkmcnt(0)
    v_mfma_f32_32x32x16_bf16 v[192:207], v[220:223], v[60:63], v[192:207]
    s_waitcnt vmcnt(16)
    ds_read_b64_tr_b16 v[224:225], v10 offset:49152
    ds_read_b64_tr_b16 v[226:227], v10 offset:50176
    ds_read_b64_tr_b16 v[228:229], v11 offset:49152
    ds_read_b64_tr_b16 v[230:231], v11 offset:50176
    ds_read_b64_tr_b16 v[232:233], v12 offset:49152
    ds_read_b64_tr_b16 v[234:235], v12 offset:50176
    ds_read_b64_tr_b16 v[236:237], v13 offset:49152
    ds_read_b64_tr_b16 v[238:239], v13 offset:50176
    ds_read_b64_tr_b16 v[240:241], v10 offset:53248
    ds_read_b64_tr_b16 v[242:243], v10 offset:54272
    ds_read_b64_tr_b16 v[244:245], v11 offset:53248
    ds_read_b64_tr_b16 v[246:247], v11 offset:54272
    ds_read_b64_tr_b16 v[248:249], v12 offset:53248
    ds_read_b64_tr_b16 v[250:251], v12 offset:54272
    s_waitcnt lgkmcnt(12)
    v_mfma_f32_32x32x16_bf16 v[144:159], v[224:227], v[64:67], v[144:159]
    ds_read_b64_tr_b16 v[252:253], v13 offset:53248
    ds_read_b64_tr_b16 v[254:255], v13 offset:54272
    s_waitcnt lgkmcnt(12)
    v_mfma_f32_32x32x16_bf16 v[160:175], v[228:231], v[64:67], v[160:175]
    ds_read_b64_tr_b16 v[208:209], v10 offset:57344
    ds_read_b64_tr_b16 v[210:211], v10 offset:58368
    s_waitcnt lgkmcnt(12)
    v_mfma_f32_32x32x16_bf16 v[176:191], v[232:235], v[64:67], v[176:191]
    ds_read_b64_tr_b16 v[212:213], v11 offset:57344
    ds_read_b64_tr_b16 v[214:215], v11 offset:58368
    s_waitcnt lgkmcnt(12)
    v_mfma_f32_32x32x16_bf16 v[192:207], v[236:239], v[64:67], v[192:207]
    ds_read_b64_tr_b16 v[216:217], v12 offset:57344
    ds_read_b64_tr_b16 v[218:219], v12 offset:58368
    s_waitcnt lgkmcnt(12)
    v_mfma_f32_32x32x16_bf16 v[144:159], v[240:243], v[68:71], v[144:159]
    ds_read_b64_tr_b16 v[220:221], v13 offset:57344
    ds_read_b64_tr_b16 v[222:223], v13 offset:58368
    s_waitcnt lgkmcnt(12)
    v_mfma_f32_32x32x16_bf16 v[160:175], v[244:247], v[68:71], v[160:175]
    ds_read_b64_tr_b16 v[224:225], v10 offset:61440
    ds_read_b64_tr_b16 v[226:227], v10 offset:62464
    s_waitcnt lgkmcnt(12)
    v_mfma_f32_32x32x16_bf16 v[176:191], v[248:251], v[68:71], v[176:191]
    ds_read_b64_tr_b16 v[228:229], v11 offset:61440
    ds_read_b64_tr_b16 v[230:231], v11 offset:62464
    s_waitcnt lgkmcnt(12)
    v_mfma_f32_32x32x16_bf16 v[192:207], v[252:255], v[68:71], v[192:207]
    ds_read_b64_tr_b16 v[232:233], v12 offset:61440
    ds_read_b64_tr_b16 v[234:235], v12 offset:62464
    s_waitcnt lgkmcnt(12)
    v_mfma_f32_32x32x16_bf16 v[144:159], v[208:211], v[72:75], v[144:159]
    ds_read_b64_tr_b16 v[236:237], v13 offset:61440
    ds_read_b64_tr_b16 v[238:239], v13 offset:62464
    s_waitcnt lgkmcnt(12)
    v_mfma_f32_32x32x16_bf16 v[160:175], v[212:215], v[72:75], v[160:175]
    s_waitcnt lgkmcnt(10)
    v_mfma_f32_32x32x16_bf16 v[176:191], v[216:219], v[72:75], v[176:191]
    s_waitcnt lgkmcnt(8)
    v_mfma_f32_32x32x16_bf16 v[192:207], v[220:223], v[72:75], v[192:207]
    s_waitcnt lgkmcnt(6)
    v_mfma_f32_32x32x16_bf16 v[144:159], v[224:227], v[76:79], v[144:159]
    s_waitcnt lgkmcnt(4)
    v_mfma_f32_32x32x16_bf16 v[160:175], v[228:231], v[76:79], v[160:175]
    s_waitcnt lgkmcnt(2)
    v_mfma_f32_32x32x16_bf16 v[176:191], v[232:235], v[76:79], v[176:191]
    s_waitcnt lgkmcnt(0)
    v_mfma_f32_32x32x16_bf16 v[192:207], v[236:239], v[76:79], v[192:207]
    s_barrier
    s_waitcnt vmcnt(12)
    ds_read_b64_tr_b16 v[240:241], v3 offset:0
    ds_read_b64_tr_b16 v[242:243], v3 offset:1024
    ds_read_b64_tr_b16 v[244:245], v4 offset:0
    ds_read_b64_tr_b16 v[246:247], v4 offset:1024
    ds_read_b64_tr_b16 v[248:249], v5 offset:0
    ds_read_b64_tr_b16 v[250:251], v5 offset:1024
    ds_read_b64_tr_b16 v[252:253], v6 offset:0
    ds_read_b64_tr_b16 v[254:255], v6 offset:1024
    ds_read_b64_tr_b16 v[208:209], v3 offset:4096
    ds_read_b64_tr_b16 v[210:211], v3 offset:5120
    ds_read_b64_tr_b16 v[212:213], v4 offset:4096
    ds_read_b64_tr_b16 v[214:215], v4 offset:5120
    ds_read_b64_tr_b16 v[216:217], v5 offset:4096
    ds_read_b64_tr_b16 v[218:219], v5 offset:5120
    s_waitcnt lgkmcnt(12)
    v_mfma_f32_32x32x16_bf16 v[144:159], v[240:243], v[80:83], v[144:159]
    ds_read_b64_tr_b16 v[220:221], v6 offset:4096
    ds_read_b64_tr_b16 v[222:223], v6 offset:5120
    s_waitcnt lgkmcnt(12)
    v_mfma_f32_32x32x16_bf16 v[160:175], v[244:247], v[80:83], v[160:175]
    ds_read_b64_tr_b16 v[224:225], v3 offset:8192
    ds_read_b64_tr_b16 v[226:227], v3 offset:9216
    s_waitcnt lgkmcnt(12)
    v_mfma_f32_32x32x16_bf16 v[176:191], v[248:251], v[80:83], v[176:191]
    ds_read_b64_tr_b16 v[228:229], v4 offset:8192
    ds_read_b64_tr_b16 v[230:231], v4 offset:9216
    s_waitcnt lgkmcnt(12)
    v_mfma_f32_32x32x16_bf16 v[192:207], v[252:255], v[80:83], v[192:207]
    ds_read_b64_tr_b16 v[232:233], v5 offset:8192
    ds_read_b64_tr_b16 v[234:235], v5 offset:9216
    s_waitcnt lgkmcnt(12)
    v_mfma_f32_32x32x16_bf16 v[144:159], v[208:211], v[84:87], v[144:159]
    ds_read_b64_tr_b16 v[236:237], v6 offset:8192
    ds_read_b64_tr_b16 v[238:239], v6 offset:9216
    s_waitcnt lgkmcnt(12)
    v_mfma_f32_32x32x16_bf16 v[160:175], v[212:215], v[84:87], v[160:175]
    ds_read_b64_tr_b16 v[240:241], v3 offset:12288
    ds_read_b64_tr_b16 v[242:243], v3 offset:13312
    s_waitcnt lgkmcnt(12)
    v_mfma_f32_32x32x16_bf16 v[176:191], v[216:219], v[84:87], v[176:191]
    ds_read_b64_tr_b16 v[244:245], v4 offset:12288
    ds_read_b64_tr_b16 v[246:247], v4 offset:13312
    s_waitcnt lgkmcnt(12)
    v_mfma_f32_32x32x16_bf16 v[192:207], v[220:223], v[84:87], v[192:207]
    ds_read_b64_tr_b16 v[248:249], v5 offset:12288
    ds_read_b64_tr_b16 v[250:251], v5 offset:13312
    s_waitcnt lgkmcnt(12)
    v_mfma_f32_32x32x16_bf16 v[144:159], v[224:227], v[88:91], v[144:159]
    ds_read_b64_tr_b16 v[252:253], v6 offset:12288
    ds_read_b64_tr_b16 v[254:255], v6 offset:13312
    s_waitcnt lgkmcnt(12)
    v_mfma_f32_32x32x16_bf16 v[160:175], v[228:231], v[88:91], v[160:175]
    s_waitcnt lgkmcnt(10)
    v_mfma_f32_32x32x16_bf16 v[176:191], v[232:235], v[88:91], v[176:191]
    s_waitcnt lgkmcnt(8)
    v_mfma_f32_32x32x16_bf16 v[192:207], v[236:239], v[88:91], v[192:207]
    s_waitcnt lgkmcnt(6)
    v_mfma_f32_32x32x16_bf16 v[144:159], v[240:243], v[92:95], v[144:159]
    s_waitcnt lgkmcnt(4)
    v_mfma_f32_32x32x16_bf16 v[160:175], v[244:247], v[92:95], v[160:175]
    s_waitcnt lgkmcnt(2)
    v_mfma_f32_32x32x16_bf16 v[176:191], v[248:251], v[92:95], v[176:191]
    s_waitcnt lgkmcnt(0)
    v_mfma_f32_32x32x16_bf16 v[192:207], v[252:255], v[92:95], v[192:207]
    s_waitcnt vmcnt(8)
    ds_read_b64_tr_b16 v[208:209], v3 offset:16384
    ds_read_b64_tr_b16 v[210:211], v3 offset:17408
    ds_read_b64_tr_b16 v[212:213], v4 offset:16384
    ds_read_b64_tr_b16 v[214:215], v4 offset:17408
    ds_read_b64_tr_b16 v[216:217], v5 offset:16384
    ds_read_b64_tr_b16 v[218:219], v5 offset:17408
    ds_read_b64_tr_b16 v[220:221], v6 offset:16384
    ds_read_b64_tr_b16 v[222:223], v6 offset:17408
    ds_read_b64_tr_b16 v[224:225], v3 offset:20480
    ds_read_b64_tr_b16 v[226:227], v3 offset:21504
    ds_read_b64_tr_b16 v[228:229], v4 offset:20480
    ds_read_b64_tr_b16 v[230:231], v4 offset:21504
    ds_read_b64_tr_b16 v[232:233], v5 offset:20480
    ds_read_b64_tr_b16 v[234:235], v5 offset:21504
    s_waitcnt lgkmcnt(12)
    v_mfma_f32_32x32x16_bf16 v[144:159], v[208:211], v[96:99], v[144:159]
    ds_read_b64_tr_b16 v[236:237], v6 offset:20480
    ds_read_b64_tr_b16 v[238:239], v6 offset:21504
    s_waitcnt lgkmcnt(12)
    v_mfma_f32_32x32x16_bf16 v[160:175], v[212:215], v[96:99], v[160:175]
    ds_read_b64_tr_b16 v[240:241], v3 offset:24576
    ds_read_b64_tr_b16 v[242:243], v3 offset:25600
    s_waitcnt lgkmcnt(12)
    v_mfma_f32_32x32x16_bf16 v[176:191], v[216:219], v[96:99], v[176:191]
    ds_read_b64_tr_b16 v[244:245], v4 offset:24576
    ds_read_b64_tr_b16 v[246:247], v4 offset:25600
    s_waitcnt lgkmcnt(12)
    v_mfma_f32_32x32x16_bf16 v[192:207], v[220:223], v[96:99], v[192:207]
    ds_read_b64_tr_b16 v[248:249], v5 offset:24576
    ds_read_b64_tr_b16 v[250:251], v5 offset:25600
    s_waitcnt lgkmcnt(12)
    v_mfma_f32_32x32x16_bf16 v[144:159], v[224:227], v[100:103], v[144:159]
    ds_read_b64_tr_b16 v[252:253], v6 offset:24576
    ds_read_b64_tr_b16 v[254:255], v6 offset:25600
    s_waitcnt lgkmcnt(12)
    v_mfma_f32_32x32x16_bf16 v[160:175], v[228:231], v[100:103], v[160:175]
    ds_read_b64_tr_b16 v[208:209], v3 offset:28672
    ds_read_b64_tr_b16 v[210:211], v3 offset:29696
    s_waitcnt lgkmcnt(12)
    v_mfma_f32_32x32x16_bf16 v[176:191], v[232:235], v[100:103], v[176:191]
    ds_read_b64_tr_b16 v[212:213], v4 offset:28672
    ds_read_b64_tr_b16 v[214:215], v4 offset:29696
    s_waitcnt lgkmcnt(12)
    v_mfma_f32_32x32x16_bf16 v[192:207], v[236:239], v[100:103], v[192:207]
    ds_read_b64_tr_b16 v[216:217], v5 offset:28672
    ds_read_b64_tr_b16 v[218:219], v5 offset:29696
    s_waitcnt lgkmcnt(12)
    v_mfma_f32_32x32x16_bf16 v[144:159], v[240:243], v[104:107], v[144:159]
    ds_read_b64_tr_b16 v[220:221], v6 offset:28672
    ds_read_b64_tr_b16 v[222:223], v6 offset:29696
    s_waitcnt lgkmcnt(12)
    v_mfma_f32_32x32x16_bf16 v[160:175], v[244:247], v[104:107], v[160:175]
    s_waitcnt lgkmcnt(10)
    v_mfma_f32_32x32x16_bf16 v[176:191], v[248:251], v[104:107], v[176:191]
    s_waitcnt lgkmcnt(8)
    v_mfma_f32_32x32x16_bf16 v[192:207], v[252:255], v[104:107], v[192:207]
    s_waitcnt lgkmcnt(6)
    v_mfma_f32_32x32x16_bf16 v[144:159], v[208:211], v[108:111], v[144:159]
    s_waitcnt lgkmcnt(4)
    v_mfma_f32_32x32x16_bf16 v[160:175], v[212:215], v[108:111], v[160:175]
    s_waitcnt lgkmcnt(2)
    v_mfma_f32_32x32x16_bf16 v[176:191], v[216:219], v[108:111], v[176:191]
    s_waitcnt lgkmcnt(0)
    v_mfma_f32_32x32x16_bf16 v[192:207], v[220:223], v[108:111], v[192:207]
    s_barrier
    s_waitcnt vmcnt(4)
    ds_read_b64_tr_b16 v[224:225], v3 offset:32768
    ds_read_b64_tr_b16 v[226:227], v3 offset:33792
    ds_read_b64_tr_b16 v[228:229], v4 offset:32768
    ds_read_b64_tr_b16 v[230:231], v4 offset:33792
    ds_read_b64_tr_b16 v[232:233], v5 offset:32768
    ds_read_b64_tr_b16 v[234:235], v5 offset:33792
    ds_read_b64_tr_b16 v[236:237], v6 offset:32768
    ds_read_b64_tr_b16 v[238:239], v6 offset:33792
    ds_read_b64_tr_b16 v[240:241], v3 offset:36864
    ds_read_b64_tr_b16 v[242:243], v3 offset:37888
    ds_read_b64_tr_b16 v[244:245], v4 offset:36864
    ds_read_b64_tr_b16 v[246:247], v4 offset:37888
    ds_read_b64_tr_b16 v[248:249], v5 offset:36864
    ds_read_b64_tr_b16 v[250:251], v5 offset:37888
    s_waitcnt lgkmcnt(12)
    v_mfma_f32_32x32x16_bf16 v[144:159], v[224:227], v[112:115], v[144:159]
    ds_read_b64_tr_b16 v[252:253], v6 offset:36864
    ds_read_b64_tr_b16 v[254:255], v6 offset:37888
    s_waitcnt lgkmcnt(12)
    v_mfma_f32_32x32x16_bf16 v[160:175], v[228:231], v[112:115], v[160:175]
    ds_read_b64_tr_b16 v[208:209], v3 offset:40960
    ds_read_b64_tr_b16 v[210:211], v3 offset:41984
    s_waitcnt lgkmcnt(12)
    v_mfma_f32_32x32x16_bf16 v[176:191], v[232:235], v[112:115], v[176:191]
    ds_read_b64_tr_b16 v[212:213], v4 offset:40960
    ds_read_b64_tr_b16 v[214:215], v4 offset:41984
    s_waitcnt lgkmcnt(12)
    v_mfma_f32_32x32x16_bf16 v[192:207], v[236:239], v[112:115], v[192:207]
    ds_read_b64_tr_b16 v[216:217], v5 offset:40960
    ds_read_b64_tr_b16 v[218:219], v5 offset:41984
    s_waitcnt lgkmcnt(12)
    v_mfma_f32_32x32x16_bf16 v[144:159], v[240:243], v[116:119], v[144:159]
    ds_read_b64_tr_b16 v[220:221], v6 offset:40960
    ds_read_b64_tr_b16 v[222:223], v6 offset:41984
    s_waitcnt lgkmcnt(12)
    v_mfma_f32_32x32x16_bf16 v[160:175], v[244:247], v[116:119], v[160:175]
    ds_read_b64_tr_b16 v[224:225], v3 offset:45056
    ds_read_b64_tr_b16 v[226:227], v3 offset:46080
    s_waitcnt lgkmcnt(12)
    v_mfma_f32_32x32x16_bf16 v[176:191], v[248:251], v[116:119], v[176:191]
    ds_read_b64_tr_b16 v[228:229], v4 offset:45056
    ds_read_b64_tr_b16 v[230:231], v4 offset:46080
    s_waitcnt lgkmcnt(12)
    v_mfma_f32_32x32x16_bf16 v[192:207], v[252:255], v[116:119], v[192:207]
    ds_read_b64_tr_b16 v[232:233], v5 offset:45056
    ds_read_b64_tr_b16 v[234:235], v5 offset:46080
    s_waitcnt lgkmcnt(12)
    v_mfma_f32_32x32x16_bf16 v[144:159], v[208:211], v[120:123], v[144:159]
    ds_read_b64_tr_b16 v[236:237], v6 offset:45056
    ds_read_b64_tr_b16 v[238:239], v6 offset:46080
    s_waitcnt lgkmcnt(12)
    v_mfma_f32_32x32x16_bf16 v[160:175], v[212:215], v[120:123], v[160:175]
    s_waitcnt lgkmcnt(10)
    v_mfma_f32_32x32x16_bf16 v[176:191], v[216:219], v[120:123], v[176:191]
    s_waitcnt lgkmcnt(8)
    v_mfma_f32_32x32x16_bf16 v[192:207], v[220:223], v[120:123], v[192:207]
    s_waitcnt lgkmcnt(6)
    v_mfma_f32_32x32x16_bf16 v[144:159], v[224:227], v[124:127], v[144:159]
    s_waitcnt lgkmcnt(4)
    v_mfma_f32_32x32x16_bf16 v[160:175], v[228:231], v[124:127], v[160:175]
    s_waitcnt lgkmcnt(2)
    v_mfma_f32_32x32x16_bf16 v[176:191], v[232:235], v[124:127], v[176:191]
    s_waitcnt lgkmcnt(0)
    v_mfma_f32_32x32x16_bf16 v[192:207], v[236:239], v[124:127], v[192:207]
    s_waitcnt vmcnt(0)
    ds_read_b64_tr_b16 v[240:241], v3 offset:49152
    ds_read_b64_tr_b16 v[242:243], v3 offset:50176
    ds_read_b64_tr_b16 v[244:245], v4 offset:49152
    ds_read_b64_tr_b16 v[246:247], v4 offset:50176
    ds_read_b64_tr_b16 v[248:249], v5 offset:49152
    ds_read_b64_tr_b16 v[250:251], v5 offset:50176
    ds_read_b64_tr_b16 v[252:253], v6 offset:49152
    ds_read_b64_tr_b16 v[254:255], v6 offset:50176
    ds_read_b64_tr_b16 v[208:209], v3 offset:53248
    ds_read_b64_tr_b16 v[210:211], v3 offset:54272
    ds_read_b64_tr_b16 v[212:213], v4 offset:53248
    ds_read_b64_tr_b16 v[214:215], v4 offset:54272
    ds_read_b64_tr_b16 v[216:217], v5 offset:53248
    ds_read_b64_tr_b16 v[218:219], v5 offset:54272
    s_waitcnt lgkmcnt(12)
    v_mfma_f32_32x32x16_bf16 v[144:159], v[240:243], v[128:131], v[144:159]
    ds_read_b64_tr_b16 v[220:221], v6 offset:53248
    ds_read_b64_tr_b16 v[222:223], v6 offset:54272
    s_waitcnt lgkmcnt(12)
    v_mfma_f32_32x32x16_bf16 v[160:175], v[244:247], v[128:131], v[160:175]
    ds_read_b64_tr_b16 v[224:225], v3 offset:57344
    ds_read_b64_tr_b16 v[226:227], v3 offset:58368
    s_waitcnt lgkmcnt(12)
    v_mfma_f32_32x32x16_bf16 v[176:191], v[248:251], v[128:131], v[176:191]
    ds_read_b64_tr_b16 v[228:229], v4 offset:57344
    ds_read_b64_tr_b16 v[230:231], v4 offset:58368
    s_waitcnt lgkmcnt(12)
    v_mfma_f32_32x32x16_bf16 v[192:207], v[252:255], v[128:131], v[192:207]
    ds_read_b64_tr_b16 v[232:233], v5 offset:57344
    ds_read_b64_tr_b16 v[234:235], v5 offset:58368
    s_waitcnt lgkmcnt(12)
    v_mfma_f32_32x32x16_bf16 v[144:159], v[208:211], v[132:135], v[144:159]
    ds_read_b64_tr_b16 v[236:237], v6 offset:57344
    ds_read_b64_tr_b16 v[238:239], v6 offset:58368
    s_waitcnt lgkmcnt(12)
    v_mfma_f32_32x32x16_bf16 v[160:175], v[212:215], v[132:135], v[160:175]
    ds_read_b64_tr_b16 v[240:241], v3 offset:61440
    ds_read_b64_tr_b16 v[242:243], v3 offset:62464
    s_waitcnt lgkmcnt(12)
    v_mfma_f32_32x32x16_bf16 v[176:191], v[216:219], v[132:135], v[176:191]
    ds_read_b64_tr_b16 v[244:245], v4 offset:61440
    ds_read_b64_tr_b16 v[246:247], v4 offset:62464
    s_waitcnt lgkmcnt(12)
    v_mfma_f32_32x32x16_bf16 v[192:207], v[220:223], v[132:135], v[192:207]
    ds_read_b64_tr_b16 v[248:249], v5 offset:61440
    ds_read_b64_tr_b16 v[250:251], v5 offset:62464
    s_waitcnt lgkmcnt(12)
    v_mfma_f32_32x32x16_bf16 v[144:159], v[224:227], v[136:139], v[144:159]
    ds_read_b64_tr_b16 v[252:253], v6 offset:61440
    ds_read_b64_tr_b16 v[254:255], v6 offset:62464
    s_waitcnt lgkmcnt(12)
    v_mfma_f32_32x32x16_bf16 v[160:175], v[228:231], v[136:139], v[160:175]
    s_waitcnt lgkmcnt(10)
    v_mfma_f32_32x32x16_bf16 v[176:191], v[232:235], v[136:139], v[176:191]
    s_waitcnt lgkmcnt(8)
    v_mfma_f32_32x32x16_bf16 v[192:207], v[236:239], v[136:139], v[192:207]
    s_waitcnt lgkmcnt(6)
    v_mfma_f32_32x32x16_bf16 v[144:159], v[240:243], v[140:143], v[144:159]
    s_waitcnt lgkmcnt(4)
    v_mfma_f32_32x32x16_bf16 v[160:175], v[244:247], v[140:143], v[160:175]
    s_waitcnt lgkmcnt(2)
    v_mfma_f32_32x32x16_bf16 v[176:191], v[248:251], v[140:143], v[176:191]
    s_waitcnt lgkmcnt(0)
    v_mfma_f32_32x32x16_bf16 v[192:207], v[252:255], v[140:143], v[192:207]
    s_nop 15
    s_mov_b32 s45, 0
    buffer_store_dwordx4 v[144:147], v15, s[16:19], s45 offen offset:0 nt
    buffer_store_dwordx4 v[148:151], v15, s[16:19], s45 offen offset:1024 nt
    buffer_store_dwordx4 v[152:155], v15, s[16:19], s45 offen offset:2048 nt
    buffer_store_dwordx4 v[156:159], v15, s[16:19], s45 offen offset:3072 nt
    s_mov_b32 s45, 4096
    buffer_store_dwordx4 v[160:163], v15, s[16:19], s45 offen offset:0 nt
    buffer_store_dwordx4 v[164:167], v15, s[16:19], s45 offen offset:1024 nt
    buffer_store_dwordx4 v[168:171], v15, s[16:19], s45 offen offset:2048 nt
    buffer_store_dwordx4 v[172:175], v15, s[16:19], s45 offen offset:3072 nt
    s_mov_b32 s45, 8192
    buffer_store_dwordx4 v[176:179], v15, s[16:19], s45 offen offset:0 nt
    buffer_store_dwordx4 v[180:183], v15, s[16:19], s45 offen offset:1024 nt
    buffer_store_dwordx4 v[184:187], v15, s[16:19], s45 offen offset:2048 nt
    buffer_store_dwordx4 v[188:191], v15, s[16:19], s45 offen offset:3072 nt
    s_mov_b32 s45, 12288
    buffer_store_dwordx4 v[192:195], v15, s[16:19], s45 offen offset:0 nt
    buffer_store_dwordx4 v[196:199], v15, s[16:19], s45 offen offset:1024 nt
    buffer_store_dwordx4 v[200:203], v15, s[16:19], s45 offen offset:2048 nt
    buffer_store_dwordx4 v[204:207], v15, s[16:19], s45 offen offset:3072 nt
L2_end:
    s_endpgm
.globl reduce_kernel
.p2align 8
.type reduce_kernel,@function
reduce_kernel:
    s_cmp_ge_u32 s2, 960
    s_cbranch_scc1 L3_end
    s_load_dwordx2 s[28:29], s[0:1], 40
    s_load_dwordx2 s[30:31], s[0:1], 56
    s_lshl_b32 s3, s2, 8
    v_add_u32 v1, s3, v0
    v_lshlrev_b32 v2, 4, v1
    s_lshr_b32 s39, s2, 4
    s_mul_i32 s41, s39, 0xcccd
    s_lshr_b32 s41, s41, 18
    s_mul_i32 s42, s41, 5
    s_sub_u32 s42, s39, s42
    s_lshr_b32 s43, s2, 2
    s_and_b32 s43, s43, 3
    s_and_b32 s44, s2, 3
    s_lshl_b32 s45, s41, 7
    s_lshl_b32 s46, s43, 5
    s_add_u32 s45, s45, s46
    s_lshl_b32 s46, s42, 7
    s_lshl_b32 s47, s44, 5
    s_add_u32 s46, s46, s47
    v_and_b32 v3, 31, v0
    v_add_u32 v3, s45, v3
    v_mul_u32_u24 v3, 0x500, v3
    v_lshrrev_b32 v4, 6, v0
    v_lshlrev_b32 v4, 3, v4
    v_bfe_u32 v5, v0, 5, 1
    v_lshl_add_u32 v4, v5, 2, v4
    v_add_u32 v4, s46, v4
    v_lshl_add_u32 v3, v4, 1, v3
    s_waitcnt lgkmcnt(0)
    s_mov_b32 s8, s28
    s_and_b32 s9, s29, 0xffff
    s_mov_b32 s10, 1966080
    s_mov_b32 s11, 0x00020000
    s_add_u32 s32, s30, 18874368
    s_addc_u32 s33, s31, 0
    s_mov_b32 s12, s32
    s_and_b32 s13, s33, 0xffff
    s_mov_b32 s14, 15728640
    s_mov_b32 s15, 0x00020000
    s_mov_b32 s37, 3932160
    s_mov_b32 s38, 7864320
    s_mov_b32 s39, 11796480
    buffer_load_dwordx4 v[8:11], v2, s[12:15], 0 offen nt
    buffer_load_dwordx4 v[12:15], v2, s[12:15], s37 offen nt
    buffer_load_dwordx4 v[16:19], v2, s[12:15], s38 offen nt
    buffer_load_dwordx4 v[20:23], v2, s[12:15], s39 offen nt
    s_waitcnt vmcnt(2)
    v_add_f32 v8, v8, v12
    v_add_f32 v9, v9, v13
    v_add_f32 v10, v10, v14
    v_add_f32 v11, v11, v15
    s_waitcnt vmcnt(0)
    v_add_f32 v16, v16, v20
    v_add_f32 v17, v17, v21
    v_add_f32 v18, v18, v22
    v_add_f32 v19, v19, v23
    v_add_f32 v8, v8, v16
    v_add_f32 v9, v9, v17
    v_add_f32 v10, v10, v18
    v_add_f32 v11, v11, v19
    v_cvt_pk_bf16_f32 v6, v8, v9
    v_cvt_pk_bf16_f32 v7, v10, v11
    buffer_store_dwordx2 v[6:7], v3, s[8:11], 0 offen
L3_end:
    s_endpgm
.section .rodata,"a"
.p2align 6
.amdhsa_kernel standalone__mha_block_cached__near_ridge_kernel
  .amdhsa_next_free_vgpr 256
  .amdhsa_next_free_sgpr 102
  .amdhsa_accum_offset 256
  .amdhsa_group_segment_fixed_size 0
  .amdhsa_kernarg_size 64
  .amdhsa_user_sgpr_count 2
  .amdhsa_user_sgpr_kernarg_segment_ptr 1
  .amdhsa_system_sgpr_workgroup_id_x 1
.end_amdhsa_kernel
.p2align 6
.amdhsa_kernel oproj_kernel
  .amdhsa_next_free_vgpr 256
  .amdhsa_next_free_sgpr 102
  .amdhsa_accum_offset 256
  .amdhsa_group_segment_fixed_size 0
  .amdhsa_kernarg_size 64
  .amdhsa_user_sgpr_count 2
  .amdhsa_user_sgpr_kernarg_segment_ptr 1
  .amdhsa_system_sgpr_workgroup_id_x 1
.end_amdhsa_kernel
.p2align 6
.amdhsa_kernel reduce_kernel
  .amdhsa_next_free_vgpr 24
  .amdhsa_next_free_sgpr 102
  .amdhsa_accum_offset 24
  .amdhsa_group_segment_fixed_size 0
  .amdhsa_kernarg_size 64
  .amdhsa_user_sgpr_count 2
  .amdhsa_user_sgpr_kernarg_segment_ptr 1
  .amdhsa_system_sgpr_workgroup_id_x 1
.end_amdhsa_kernel
```
